```python
import torch

def _softmax(x, axis=-1):
    return torch.softmax(x, dim=axis)
def _gelu(x):
    return torch.nn.functional.gelu(x, approximate="tanh")
def _silu(x):
    return torch.nn.functional.silu(x)
def _sigmoid(x):
    return torch.sigmoid(x)
def _layernorm(x, axis=-1, eps=1e-5):
    m = x.mean(dim=axis, keepdim=True)
    v = x.var(dim=axis, keepdim=True, unbiased=False)
    return (x - m) / torch.sqrt(v + eps)
def _scatter_add(tgt, idx, src, axis=0):
    return tgt.clone().index_add_(axis, idx, src)
def _segment_sum(src, seg, n):
    out = torch.zeros((n,) + src.shape[1:], dtype=src.dtype)
    return out.index_add_(0, seg, src)
def _pad(x, pw):
    flat = tuple(v for pair in reversed(pw) for v in pair)
    return torch.nn.functional.pad(x, flat)

kernel_name = 'gated_mix__ssm_conv_s5__ssm_conv_s5__prompt'

def setup_inputs():

    _w = (lambda a: (lambda t: t.to(torch.bfloat16) if t.is_floating_point() else t)(torch.as_tensor(a)))
    def _A_setup():
        B, S, D = 1, 2048, 640
        P = D
        Lambda_re = -0.5 * (lambda _x: torch.exp(torch.as_tensor(_x)))((lambda *s: torch.randn(*s, dtype=torch.bfloat16) * 0.2)(P))
        Lambda_im = (lambda *s: torch.randn(*s, dtype=torch.bfloat16) * 0.4)(P) * 1.0
        B_re = (lambda *s: torch.randn(*s, dtype=torch.bfloat16) * 0.2)(P, D) * (D ** -0.5)
        B_im = (lambda *s: torch.randn(*s, dtype=torch.bfloat16) * 0.2)(P, D) * (D ** -0.5)
        C_re = (lambda *s: torch.randn(*s, dtype=torch.bfloat16) * 0.2)(D, P) * (P ** -0.5)
        C_im = (lambda *s: torch.randn(*s, dtype=torch.bfloat16) * 0.2)(D, P) * (P ** -0.5)
        log_dt = (lambda *s: torch.randn(*s, dtype=torch.bfloat16) * 0.2)(P) * 0.3 - 2.0
        Dskip = (lambda *s: torch.randn(*s, dtype=torch.bfloat16) * 0.05)(D)
        return {
            "x": _w((lambda *s: torch.randn(*s, dtype=torch.bfloat16) * 0.05)(B, S, D)),
            "Lambda_re": _w(Lambda_re),
            "Lambda_im": _w(Lambda_im),
            "B_re": _w(B_re),
            "B_im": _w(B_im),
            "C_re": _w(C_re),
            "C_im": _w(C_im),
            "log_dt": _w(log_dt),
            "Dskip": _w(Dskip),
        }
    _A_in = _A_setup()

    def _B_setup():
        B, S, D = 1, 2048, 640
        P = D
        Lambda_re = -0.5 * (lambda _x: torch.exp(torch.as_tensor(_x)))((lambda *s: torch.randn(*s, dtype=torch.bfloat16) * 0.2)(P))
        Lambda_im = (lambda *s: torch.randn(*s, dtype=torch.bfloat16) * 0.4)(P) * 1.0
        B_re = (lambda *s: torch.randn(*s, dtype=torch.bfloat16) * 0.2)(P, D) * (D ** -0.5)
        B_im = (lambda *s: torch.randn(*s, dtype=torch.bfloat16) * 0.2)(P, D) * (D ** -0.5)
        C_re = (lambda *s: torch.randn(*s, dtype=torch.bfloat16) * 0.2)(D, P) * (P ** -0.5)
        C_im = (lambda *s: torch.randn(*s, dtype=torch.bfloat16) * 0.2)(D, P) * (P ** -0.5)
        log_dt = (lambda *s: torch.randn(*s, dtype=torch.bfloat16) * 0.2)(P) * 0.3 - 2.0
        Dskip = (lambda *s: torch.randn(*s, dtype=torch.bfloat16) * 0.05)(D)
        return {
            "x": _w((lambda *s: torch.randn(*s, dtype=torch.bfloat16) * 0.05)(B, S, D)),
            "Lambda_re": _w(Lambda_re),
            "Lambda_im": _w(Lambda_im),
            "B_re": _w(B_re),
            "B_im": _w(B_im),
            "C_re": _w(C_re),
            "C_im": _w(C_im),
            "log_dt": _w(log_dt),
            "Dskip": _w(Dskip),
        }
    _B_in = _B_setup()

    return {
        "A_x": _A_in["x"],
        "A_Lambda_re": _A_in["Lambda_re"],
        "A_Lambda_im": _A_in["Lambda_im"],
        "A_B_re": _A_in["B_re"],
        "A_B_im": _A_in["B_im"],
        "A_C_re": _A_in["C_re"],
        "A_C_im": _A_in["C_im"],
        "A_log_dt": _A_in["log_dt"],
        "A_Dskip": _A_in["Dskip"],
        "B_x": _B_in["x"],
        "B_Lambda_re": _B_in["Lambda_re"],
        "B_Lambda_im": _B_in["Lambda_im"],
        "B_B_re": _B_in["B_re"],
        "B_B_im": _B_in["B_im"],
        "B_C_re": _B_in["C_re"],
        "B_C_im": _B_in["C_im"],
        "B_log_dt": _B_in["log_dt"],
        "B_Dskip": _B_in["Dskip"],
        "gate_w": _w((lambda *s: torch.randn(*s, dtype=torch.bfloat16) * 0.05)(640) * 16.0),
    }

def reference(A_x, A_Lambda_re, A_Lambda_im, A_B_re, A_B_im, A_C_re, A_C_im, A_log_dt, A_Dskip, B_x, B_Lambda_re, B_Lambda_im, B_B_re, B_B_im, B_C_re, B_C_im, B_log_dt, B_Dskip, gate_w):
    def _A_ref(x, Lambda_re, Lambda_im, B_re, B_im, C_re, C_im, log_dt, Dskip):
        Bsz, L, H = x.shape
        Lam = Lambda_re + 1j * Lambda_im
        Bmat = B_re + 1j * B_im
        Cmat = C_re + 1j * C_im
        dt = torch.exp(log_dt)
        Lam_bar = torch.exp(dt * Lam)
        B_bar = ((Lam_bar - 1.0) / Lam)[:, None] * Bmat
        Bu = torch.einsum("bld,pd->blp", x + 0j, B_bar)
        h = torch.zeros_like(Bu[:, 0, :])
        hs = []
        for t in range(L):
            h = Lam_bar[None, :] * h + Bu[:, t, :]
            hs.append(h)
        hseq = torch.stack(hs, 1)
        y = 2.0 * torch.einsum("blp,dp->bld", hseq, Cmat).real + x * Dskip[None, None, :]
        return y

    def _B_ref(x, Lambda_re, Lambda_im, B_re, B_im, C_re, C_im, log_dt, Dskip):
        Bsz, L, H = x.shape
        Lam = Lambda_re + 1j * Lambda_im
        Bmat = B_re + 1j * B_im
        Cmat = C_re + 1j * C_im
        dt = torch.exp(log_dt)
        Lam_bar = torch.exp(dt * Lam)
        B_bar = ((Lam_bar - 1.0) / Lam)[:, None] * Bmat
        Bu = torch.einsum("bld,pd->blp", x + 0j, B_bar)
        h = torch.zeros_like(Bu[:, 0, :])
        hs = []
        for t in range(L):
            h = Lam_bar[None, :] * h + Bu[:, t, :]
            hs.append(h)
        hseq = torch.stack(hs, 1)
        y = 2.0 * torch.einsum("blp,dp->bld", hseq, Cmat).real + x * Dskip[None, None, :]
        return y

    x = A_x
    g = _sigmoid((x * gate_w).sum(-1, keepdims=True))
    a = _A_ref(x, A_Lambda_re, A_Lambda_im, A_B_re, A_B_im, A_C_re, A_C_im, A_log_dt, A_Dskip)
    b = _B_ref(x, B_Lambda_re, B_Lambda_im, B_B_re, B_B_im, B_C_re, B_C_im, B_log_dt, B_Dskip)
    return g * a + (1 - g) * b
```

```asm
; @launch grid=(256,1,1) block=(256,1,1) lds=163840
.amdgcn_target "amdgcn-amd-amdhsa--gfx950"
.text
.globl gated_mix__ssm_conv_s5__ssm_conv_s5__prompt_kernel
.p2align 8
.type gated_mix__ssm_conv_s5__ssm_conv_s5__prompt_kernel,@function
gated_mix__ssm_conv_s5__ssm_conv_s5__prompt_kernel:
    s_load_dwordx16 s[40:55], s[0:1], 0
    s_load_dwordx16 s[56:71], s[0:1], 64
    s_load_dwordx8 s[72:79], s[0:1], 128
    s_load_dwordx2 s[80:81], s[0:1], 168
    s_cmp_ge_u32 s2, 0x100
    s_cbranch_scc1 L_end
    v_lshrrev_b32 v18, 6, v0
    s_and_b32 s14, s2, 7
    s_lshr_b32 s15, s2, 3
    v_readfirstlane_b32 s8, v18
    s_lshr_b32 s12, s2, 3
    s_lshl_b32 s12, s12, 2
    s_add_u32 s12, s12, s8
    s_lshl_b32 s12, s12, 8
    v_and_b32 v18, 1, v0
    v_lshl_add_u32 v18, v18, 7, s12
    s_getpc_b64 s[12:13]
L_pc1:
    v_min_u32 v18, L_last-L_pc1, v18
    s_mov_b64 exec, 3
    global_load_dword a254, v18, s[12:13]
    s_mov_b64 exec, -1
    s_lshr_b32 s4, s14, 1
    s_lshl_b32 s4, s4, 2
    s_lshr_b32 s12, s15, 3
    s_add_u32 s4, s4, s12
    s_and_b32 s7, s14, 1
    s_and_b32 s13, s15, 7
    s_lshl_b32 s5, s7, 3
    s_add_u32 s5, s5, s13
    s_mov_b32 s11, 0
    v_and_b32 v196, 63, v0
    v_lshrrev_b32 v197, 3, v196
    v_and_b32 v198, 7, v196
    v_lshrrev_b32 v251, 4, v196
    v_xor_b32 v199, v251, v198
    v_lshlrev_b32 v199, 4, v199
    v_lshrrev_b32 v246, 5, v196
    v_and_b32 v247, 3, v197
    v_lshl_add_u32 v246, v246, 3, v247
    v_mul_u32_u24 v246, 1280, v246
    v_xor_b32 v247, 64, v199
    v_add_u32 v1, v246, v199
    v_add_u32_e64 v2, v246, v247
    v_add_u32 v2, 19456, v2
    v_add_u32 v3, 3072, v1
    v_add_u32 v4, 3072, v2
    v_mul_u32_u24 v246, 1280, v197
    v_add_u32 v18, v246, v199
    v_add_u32 v19, v246, v247
    v_add_u32 v19, 10240, v19
    s_mul_i32 s9, s8, 9216
    s_bitcmp1_b32 s8, 1
    s_cselect_b64 vcc, -1, 0
    s_mul_i32 s13, s13, 80
    s_mul_i32 s12, s8, 20
    v_cndmask_b32 v5, v18, v19, vcc
    v_add_u32 v6, 19456, v5
    v_add_u32 v7, 38912, v5
    v_add_u32 v8, 58368, v5
    v_add_u32 v9, 81920, v5
    v_add_u32 v19, -1024, v19
    v_min_u32 v246, 19, v196
    v_add_u32 v204, s12, v246
    v_add_lshl_u32 v246, v204, s13, 1
    s_mul_i32 s13, s13, 1280
    s_lshl_b32 s12, s4, 2
    s_add_u32 s12, s12, s8
    s_mul_i32 s12, s12, 40960
    s_lshl_b32 s28, s15, 2
    s_add_u32 s28, s28, s8
    s_lshl_b32 s29, s14, 7
    s_add_u32 s29, s29, s28
    s_mul_i32 s29, s29, 2560
    s_bfe_u32 s30, s14, 0x10001
    s_lshl_b32 s30, s30, 7
    s_add_u32 s30, s30, s28
    s_mul_i32 s30, s30, 3200
    v_lshlrev_b32_e64 v241, 7, v196
    s_lshl_b32 s31, s2, 2
    s_add_u32 s31, s31, s8
    s_mul_i32 s31, s31, 640
    s_add_u32 s31, s31, 4096
    v_add_u32 v240, s31, v241
    v_add_u32 v242, s30, v241
    v_add_u32_e64 v241, s29, v241
    s_mov_b32 s19, 0x20000
    s_mov_b32 s23, 0x20000
    s_sub_u32 s18, 2621440, s12
    s_sub_u32 s22, 819200, s13
    s_waitcnt lgkmcnt(0)
    s_add_u32 s16, s40, s12
    s_addc_u32 s17, s41, 0
    s_cmp_eq_u32 s7, 1
    s_cselect_b64 s[46:47], s[64:65], s[46:47]
    s_cselect_b64 s[48:49], s[66:67], s[48:49]
    s_cselect_b64 s[42:43], s[60:61], s[42:43]
    s_cselect_b64 s[44:45], s[62:63], s[44:45]
    s_cselect_b64 s[54:55], s[72:73], s[54:55]
    s_cselect_b64 s[50:51], s[68:69], s[50:51]
    s_cselect_b64 s[52:53], s[70:71], s[52:53]
    s_bitcmp1_b32 s8, 0
    s_cselect_b64 s[20:21], s[48:49], s[46:47]
    s_cselect_b64 s[24:25], s[52:53], s[50:51]
    s_add_u32 s20, s20, s13
    s_addc_u32 s21, s21, 0
    global_load_ushort v206, v246, s[42:43]
    global_load_ushort v207, v246, s[44:45]
    global_load_ushort v208, v246, s[54:55]
    s_bitcmp1_b32 s14, 2
    s_cselect_b64 s[32:33], s[48:49], s[46:47]
    s_mov_b64 exec, 0xfffff
    global_load_dword v244, v241, s[40:41]
    s_mov_b64 exec, 0x1ffffff
    global_load_dword v245, v242, s[32:33]
    s_mov_b64 exec, -1
    s_add_u32 m0, s9, 0
    s_nop 0
    buffer_load_dwordx4 v1, s[16:19], s11 offen offset:0 lds
    buffer_load_dwordx4 v2, s[16:19], s11 offen offset:1024 lds
    buffer_load_dwordx4 v3, s[16:19], s11 offen offset:2048 lds
    buffer_load_dwordx4 v4, s[16:19], s11 offen offset:3072 lds
    s_add_u32 m0, s9, 4096
    s_nop 0
    buffer_load_dwordx4 v5, s[20:23], s11 offen offset:0 lds
    buffer_load_dwordx4 v6, s[20:23], s11 offen offset:1024 lds
    buffer_load_dwordx4 v7, s[20:23], s11 offen offset:2048 lds
    buffer_load_dwordx4 v8, s[20:23], s11 offen offset:3072 lds
    s_add_u32 m0, s9, 8192
    s_nop 0
    buffer_load_dwordx4 v9, s[20:23], s11 offen offset:0 lds
    s_add_u32 s11, s11, 128
    s_load_dword s10, s[80:81], 0
    v_lshlrev_b32 v204, 3, v204
    v_add_u32 v204, 147456, v204
    v_and_b32 v248, 15, v196
    v_lshrrev_b32 v246, 1, v248
    v_xor_b32 v246, v246, v251
    v_lshlrev_b32 v246, 4, v246
    v_lshl_add_u32 v247, v248, 7, v246
    v_add_u32 v10, s9, v247
    v_xor_b32 v11, 64, v10
    v_add_u32 v12, 73728, v10
    v_add_u32 v13, 73728, v11
    v_and_b32_e64 v247, 7, v248
    v_lshl_add_u32 v246, v247, 7, v246
    v_lshrrev_b32_e64 v247, 3, v248
    v_mul_u32_u24 v247, 18432, v247
    v_add_u32 v246, 4096, v246
    v_add_u32 v14, v246, v247
    v_xor_b32 v15, 64, v14
    v_add_u32 v16, 73728, v14
    v_add_u32 v17, 73728, v15
    v_lshlrev_b32_e64 v250, 3, v248
    v_add_u32 v250, 147456, v250
    s_lshr_b32 s12, s8, 1
    s_mul_i32 s12, s12, 640
    s_add_u32 s12, s12, s13
    s_add_u32 s24, s24, s12
    s_addc_u32 s25, s25, 0
    s_sub_u32 s26, 819200, s12
    s_mov_b32 s27, 0x20000
    s_mov_b32 s32, s80
    s_mov_b32 s33, s81
    s_mov_b32 s34, 16515072
    s_mov_b32 s35, 0x20000
    s_mov_b32 s36, s78
    s_mov_b32 s37, s79
    s_mov_b32 s38, 5242880
    s_mov_b32 s39, 0x20000
    s_and_b32 s12, s5, 7
    s_and_b32 s14, s4, 3
    s_add_u32 s12, s12, s14
    s_sub_u32 s14, s12, 5
    s_cselect_b32 s12, s12, s14
    s_sub_u32 s14, s12, 5
    s_cselect_b32 s12, s12, s14
    s_and_b32 s65, s5, 0
    s_add_u32 s65, s65, s8
    s_add_u32 s6, s65, 1
    s_and_b32 s6, s6, 3
    s_lshl_b32 s60, s12, 7
    s_add_u32 s61, s60, 128
    s_cmp_eq_u32 s61, 640
    s_cselect_b32 s61, 0, s61
    s_add_u32 s62, s61, 128
    s_cmp_eq_u32 s62, 640
    s_cselect_b32 s62, 0, s62
    s_add_u32 s63, s62, 128
    s_cmp_eq_u32 s63, 640
    s_cselect_b32 s63, 0, s63
    s_add_u32 s64, s63, 128
    s_cmp_eq_u32 s64, 640
    s_cselect_b32 s64, 0, s64
    s_mul_i32 s12, s8, 320
    v_lshl_add_u32 v236, v196, 4, s12
    s_add_u32 s66, s12, 162176
    s_and_b32 s12, s5, 7
    s_mul_i32 s12, s12, 160
    v_lshl_add_u32 v237, v196, 4, s12
    s_bitcmp1_b32 s8, 0
    s_cselect_b64 s[68:69], s[74:75], s[56:57]
    s_cselect_b32 s67, 160, 0
    s_add_u32 s67, s67, 163456
    s_lshl_b32 s12, s5, 4
    s_add_u32 s28, s12, s4
    s_mul_i32 s28, s28, 1280
    s_add_u32 s28, s28, 266240
    s_lshl_b32 s14, s8, 2
    s_add_u32 s29, s12, s14
    s_mul_i32 s29, s29, 1280
    s_add_u32 s29, s29, 266240
    s_lshl_b32 s12, s4, 1
    s_add_u32 s12, s12, s7
    s_lshr_b32 s14, s8, 1
    s_and_b32 s15, s8, 1
    s_lshl_b32 s30, s12, 1
    s_add_u32 s30, s30, s14
    s_mul_i32 s30, s30, 163840
    s_bfe_u32 s31, s5, 0x10002
    s_mul_i32 s31, s31, 40960
    s_add_u32 s30, s30, s31
    s_and_b32 s31, s5, 3
    s_mul_i32 s31, s31, 2560
    s_add_u32 s30, s30, s31
    s_mul_i32 s31, s15, 20480
    s_add_u32 s30, s30, s31
    s_add_u32 s30, s30, 655360
    s_add_u32 s31, s30, 81920
    s_lshl_b32 s85, s12, 1
    s_add_u32 s85, s85, s7
    s_xor_b32 s84, s85, 1
    s_mul_i32 s86, s15, 81920
    s_mul_i32 s87, s14, 40960
    s_add_u32 s86, s86, s87
    s_add_u32 s86, s86, 655360
    s_mul_i32 s84, s84, 163840
    s_mul_i32 s85, s85, 163840
    s_add_u32 s84, s84, s86
    s_add_u32 s85, s85, s86
    s_lshl_b32 s82, s4, 4
    s_add_u32 s82, s82, s5
    s_lshl_b32 s82, s82, 2
    s_add_u32 s82, s82, s8
    s_lshl_b32 s82, s82, 7
    s_add_u32 s82, s82, 4096
    s_lshl_b32 s83, s12, 12
    s_add_u32 s83, s83, 4096
    s_lshl_b32 s86, s4, 3
    s_and_b32 s12, s5, 7
    s_add_u32 s86, s86, s12
    s_lshl_b32 s86, s86, 1
    s_add_u32 s86, s86, s7
    s_lshl_b32 s86, s86, 2
    s_add_u32 s86, s86, s8
    s_xor_b32 s87, s86, 4
    v_lshlrev_b32 v209, 3, v196
    v_add_u32 v209, 157696, v209
    v_mov_b64_e64 v[132:133], 0
    s_mov_b32 exec_hi, 0xffff
    ds_write_b64 v209, v[132:133] offset:0
    ds_write_b64 v209, v[132:133] offset:896
    ds_write_b64 v209, v[132:133] offset:1792
    ds_write_b64 v209, v[132:133] offset:2688
    ds_write_b64 v209, v[132:133] offset:3584
    s_mov_b64 exec, 0xfffff
    s_waitcnt vmcnt(11)
    v_lshlrev_b32 v208, 16, v208
    v_lshlrev_b32_e64 v206, 16, v206
    v_mul_f32 v208, 0x3fb8aa3b, v208
    v_exp_f32 v208, v208
    v_lshlrev_b32 v207, 16, v207
    v_cvt_pk_bf16_f32 v208, v208, v208
    v_lshlrev_b32 v208, 16, v208
    v_mul_f32 v209, v208, v206
    v_mul_f32_e64 v210, v208, v207
    v_mul_f32 v209, 0x3fb8aa3b, v209
    v_mul_f32 v210, 0x3e22f983, v210
    v_exp_f32 v209, v209
    v_rndne_f32 v211, v210
    v_sub_f32 v210, v210, v211
    v_cos_f32 v211, v210
    v_sin_f32 v210, v210
    v_mov_b32 v100, 1.0
    v_mov_b32 v101, 0
    v_mul_f32 v102, v209, v211
    v_mul_f32 v103, v209, v210
    v_mul_f32 v209, v206, v206
    v_fmac_f32 v209, v207, v207
    v_rcp_f32 v209, v209
    v_add_f32 v210, -1.0, v102
    v_mul_f32 v106, v210, v206
    v_mul_f32 v107, v103, v206
    v_add_f32 v209, v209, v209
    v_fmac_f32 v106, v103, v207
    v_fma_f32 v107, -v210, v207, v107
    v_mul_f32 v106, v106, v209
    v_mul_f32 v107, v107, v209
    v_pk_mul_f32 v[104:105], v[102:103], v[102:103] op_sel_hi:[1,0]
    v_pk_fma_f32 v[104:105], v[102:103], v[102:103], v[104:105] op_sel:[1,1,0] op_sel_hi:[0,1,1] neg_lo:[1,0,0]
    v_pk_mul_f32 v[134:135], v[104:105], v[104:105] op_sel_hi:[1,0]
    v_pk_fma_f32 v[134:135], v[104:105], v[104:105], v[134:135] op_sel:[1,1,0] op_sel_hi:[0,1,1] neg_lo:[1,0,0]
    v_pk_mul_f32 v[108:109], v[134:135], v[134:135] op_sel_hi:[1,0]
    v_pk_fma_f32 v[108:109], v[134:135], v[134:135], v[108:109] op_sel:[1,1,0] op_sel_hi:[0,1,1] neg_lo:[1,0,0]
    v_pk_mul_f32 v[110:111], v[108:109], v[108:109] op_sel_hi:[1,0]
    v_pk_fma_f32 v[110:111], v[108:109], v[108:109], v[110:111] op_sel:[1,1,0] op_sel_hi:[0,1,1] neg_lo:[1,0,0]
    v_pk_mul_f32 v[112:113], v[110:111], v[108:109] op_sel_hi:[1,0]
    v_pk_fma_f32 v[112:113], v[110:111], v[108:109], v[112:113] op_sel:[1,1,0] op_sel_hi:[0,1,1] neg_lo:[1,0,0]
    v_pk_mul_f32 v[114:115], v[110:111], v[110:111] op_sel_hi:[1,0]
    v_pk_fma_f32 v[114:115], v[110:111], v[110:111], v[114:115] op_sel:[1,1,0] op_sel_hi:[0,1,1] neg_lo:[1,0,0]
    v_pk_mul_f32 v[116:117], v[114:115], v[114:115] op_sel_hi:[1,0]
    v_pk_fma_f32 v[116:117], v[114:115], v[114:115], v[116:117] op_sel:[1,1,0] op_sel_hi:[0,1,1] neg_lo:[1,0,0]
    v_pk_mul_f32 v[118:119], v[116:117], v[114:115] op_sel_hi:[1,0]
    v_pk_fma_f32 v[118:119], v[116:117], v[114:115], v[118:119] op_sel:[1,1,0] op_sel_hi:[0,1,1] neg_lo:[1,0,0]
    v_pk_mul_f32 v[120:121], v[116:117], v[116:117] op_sel_hi:[1,0]
    v_pk_fma_f32 v[120:121], v[116:117], v[116:117], v[120:121] op_sel:[1,1,0] op_sel_hi:[0,1,1] neg_lo:[1,0,0]
    v_pk_mul_f32 v[122:123], v[120:121], v[120:121] op_sel_hi:[1,0]
    v_pk_fma_f32 v[122:123], v[120:121], v[120:121], v[122:123] op_sel:[1,1,0] op_sel_hi:[0,1,1] neg_lo:[1,0,0]
    v_pk_mul_f32 v[124:125], v[122:123], v[120:121] op_sel_hi:[1,0]
    v_pk_fma_f32 v[124:125], v[122:123], v[120:121], v[124:125] op_sel:[1,1,0] op_sel_hi:[0,1,1] neg_lo:[1,0,0]
    v_pk_mul_f32 v[126:127], v[122:123], v[122:123] op_sel_hi:[1,0]
    v_pk_fma_f32 v[126:127], v[122:123], v[122:123], v[126:127] op_sel:[1,1,0] op_sel_hi:[0,1,1] neg_lo:[1,0,0]
    v_pk_mul_f32 v[128:129], v[126:127], v[126:127] op_sel_hi:[1,0]
    v_pk_fma_f32 v[128:129], v[126:127], v[126:127], v[128:129] op_sel:[1,1,0] op_sel_hi:[0,1,1] neg_lo:[1,0,0]
    v_pk_mul_f32 v[130:131], v[128:129], v[126:127] op_sel_hi:[1,0]
    v_pk_fma_f32 v[130:131], v[128:129], v[126:127], v[130:131] op_sel:[1,1,0] op_sel_hi:[0,1,1] neg_lo:[1,0,0]
    ds_write_b64 v204, v[100:101] offset:0
    ds_write_b64 v204, v[102:103] offset:640
    ds_write_b64 v204, v[104:105] offset:1280
    ds_write_b64 v204, v[106:107] offset:1920
    ds_write_b64 v204, v[108:109] offset:2560
    ds_write_b64 v204, v[110:111] offset:3200
    ds_write_b64 v204, v[112:113] offset:3840
    ds_write_b64 v204, v[114:115] offset:4480
    ds_write_b64 v204, v[116:117] offset:5120
    ds_write_b64 v204, v[118:119] offset:5760
    ds_write_b64 v204, v[120:121] offset:6400
    ds_write_b64 v204, v[122:123] offset:7040
    ds_write_b64 v204, v[124:125] offset:7680
    ds_write_b64 v204, v[126:127] offset:8320
    ds_write_b64 v204, v[128:129] offset:8960
    ds_write_b64 v204, v[130:131] offset:9600
    s_mov_b64 exec, -1
    s_add_u32 m0, s9, 36864
    s_nop 0
    buffer_load_dwordx4 v1, s[16:19], s11 offen offset:0 lds
    buffer_load_dwordx4 v2, s[16:19], s11 offen offset:1024 lds
    buffer_load_dwordx4 v3, s[16:19], s11 offen offset:2048 lds
    buffer_load_dwordx4 v4, s[16:19], s11 offen offset:3072 lds
    s_add_u32 m0, s9, 40960
    s_nop 0
    buffer_load_dwordx4 v5, s[20:23], s11 offen offset:0 lds
    buffer_load_dwordx4 v6, s[20:23], s11 offen offset:1024 lds
    buffer_load_dwordx4 v7, s[20:23], s11 offen offset:2048 lds
    buffer_load_dwordx4 v8, s[20:23], s11 offen offset:3072 lds
    s_add_u32 m0, s9, 45056
    s_nop 0
    buffer_load_dwordx4 v9, s[20:23], s11 offen offset:0 lds
    s_add_u32 s11, s11, 128
    s_waitcnt lgkmcnt(0)
    s_mul_i32 s10, s10, 0x9E3779B1
    s_add_u32 s10, s10, 0x7F4A7C15
    s_mov_b32 m0, s66
    s_mov_b64 exec, 0xfffff
    global_load_lds_dwordx4 v236, s[76:77]
    s_mov_b32 m0, s67
    s_mov_b64 exec, 0x3ff
    global_load_lds_dwordx4 v237, s[68:69]
    s_mov_b64 exec, -1
    s_waitcnt vmcnt(11)
    s_barrier
    ds_read_b128 v[100:103], v10 offset:0
    ds_read_b128 v[108:111], v14 offset:0
    ds_read_b128 v[104:107], v10 offset:2048
    ds_read_b128 v[112:115], v14 offset:9216
    ds_read_b128 v[116:119], v14 offset:1024
    ds_read_b128 v[120:123], v14 offset:10240
    ds_read_b128 v[124:127], v14 offset:2048
    ds_read_b128 v[128:131], v14 offset:11264
    ds_read_b128 v[132:135], v14 offset:3072
    ds_read_b128 v[136:139], v14 offset:12288
    ds_read_b128 v[140:143], v14 offset:4096
    ds_read_b128 v[144:147], v14 offset:13312
    s_waitcnt lgkmcnt(0)
    v_mfma_f32_16x16x32_bf16 v[20:23], v[100:103], v[108:111], 0
    ds_read_b128 v[148:151], v11 offset:0
    v_mfma_f32_16x16x32_bf16 v[24:27], v[104:107], v[108:111], 0
    ds_read_b128 v[156:159], v15 offset:0
    s_add_u32 m0, s9, 73728
    v_mfma_f32_16x16x32_bf16 v[28:31], v[100:103], v[112:115], 0
    ds_read_b128 v[152:155], v11 offset:2048
    v_mfma_f32_16x16x32_bf16 v[32:35], v[104:107], v[112:115], 0
    ds_read_b128 v[160:163], v15 offset:9216
    buffer_load_dwordx4 v1, s[16:19], s11 offen offset:0 lds
    v_mfma_f32_16x16x32_bf16 v[36:39], v[100:103], v[116:119], 0
    ds_read_b128 v[164:167], v15 offset:1024
    v_mfma_f32_16x16x32_bf16 v[40:43], v[104:107], v[116:119], 0
    ds_read_b128 v[168:171], v15 offset:10240
    v_mfma_f32_16x16x32_bf16 v[44:47], v[100:103], v[120:123], 0
    ds_read_b128 v[172:175], v15 offset:2048
    buffer_load_dwordx4 v2, s[16:19], s11 offen offset:1024 lds
    v_mfma_f32_16x16x32_bf16 v[48:51], v[104:107], v[120:123], 0
    ds_read_b128 v[176:179], v15 offset:11264
    v_mfma_f32_16x16x32_bf16 v[52:55], v[100:103], v[124:127], 0
    ds_read_b128 v[180:183], v15 offset:3072
    v_mfma_f32_16x16x32_bf16 v[56:59], v[104:107], v[124:127], 0
    ds_read_b128 v[184:187], v15 offset:12288
    buffer_load_dwordx4 v3, s[16:19], s11 offen offset:2048 lds
    v_mfma_f32_16x16x32_bf16 v[60:63], v[100:103], v[128:131], 0
    ds_read_b128 v[188:191], v15 offset:4096
    v_mfma_f32_16x16x32_bf16 v[64:67], v[104:107], v[128:131], 0
    ds_read_b128 v[192:195], v15 offset:13312
    buffer_load_dwordx4 v4, s[16:19], s11 offen offset:3072 lds
    v_mfma_f32_16x16x32_bf16 v[68:71], v[100:103], v[132:135], 0
    v_mfma_f32_16x16x32_bf16 v[72:75], v[104:107], v[132:135], 0
    v_mfma_f32_16x16x32_bf16 v[76:79], v[100:103], v[136:139], 0
    s_add_u32 m0, s9, 77824
    v_mfma_f32_16x16x32_bf16 v[80:83], v[104:107], v[136:139], 0
    v_mfma_f32_16x16x32_bf16 v[84:87], v[100:103], v[140:143], 0
    v_mfma_f32_16x16x32_bf16 v[88:91], v[104:107], v[140:143], 0
    buffer_load_dwordx4 v5, s[20:23], s11 offen offset:0 lds
    v_mfma_f32_16x16x32_bf16 v[92:95], v[100:103], v[144:147], 0
    v_mfma_f32_16x16x32_bf16 v[96:99], v[104:107], v[144:147], 0
    s_waitcnt vmcnt(7) lgkmcnt(0)
    s_barrier
    v_mfma_f32_16x16x32_bf16 v[20:23], v[148:151], v[156:159], v[20:23]
    ds_read_b128 v[100:103], v10 offset:36864
    v_mfma_f32_16x16x32_bf16 v[24:27], v[152:155], v[156:159], v[24:27]
    ds_read_b128 v[108:111], v14 offset:36864
    buffer_load_dwordx4 v6, s[20:23], s11 offen offset:1024 lds
    v_mfma_f32_16x16x32_bf16 v[28:31], v[148:151], v[160:163], v[28:31]
    ds_read_b128 v[104:107], v10 offset:38912
    v_mfma_f32_16x16x32_bf16 v[32:35], v[152:155], v[160:163], v[32:35]
    ds_read_b128 v[112:115], v14 offset:46080
    buffer_load_dwordx4 v7, s[20:23], s11 offen offset:2048 lds
    v_mfma_f32_16x16x32_bf16 v[36:39], v[148:151], v[164:167], v[36:39]
    ds_read_b128 v[116:119], v14 offset:37888
    v_mfma_f32_16x16x32_bf16 v[40:43], v[152:155], v[164:167], v[40:43]
    ds_read_b128 v[120:123], v14 offset:47104
    buffer_load_dwordx4 v8, s[20:23], s11 offen offset:3072 lds
    v_mfma_f32_16x16x32_bf16 v[44:47], v[148:151], v[168:171], v[44:47]
    ds_read_b128 v[124:127], v14 offset:38912
    v_mfma_f32_16x16x32_bf16 v[48:51], v[152:155], v[168:171], v[48:51]
    ds_read_b128 v[128:131], v14 offset:48128
    v_mfma_f32_16x16x32_bf16 v[52:55], v[148:151], v[172:175], v[52:55]
    ds_read_b128 v[132:135], v14 offset:39936
    s_add_u32 m0, s9, 81920
    v_mfma_f32_16x16x32_bf16 v[56:59], v[152:155], v[172:175], v[56:59]
    ds_read_b128 v[136:139], v14 offset:49152
    v_mfma_f32_16x16x32_bf16 v[60:63], v[148:151], v[176:179], v[60:63]
    ds_read_b128 v[140:143], v14 offset:40960
    buffer_load_dwordx4 v9, s[20:23], s11 offen offset:0 lds
    v_mfma_f32_16x16x32_bf16 v[64:67], v[152:155], v[176:179], v[64:67]
    ds_read_b128 v[144:147], v14 offset:50176
    v_mfma_f32_16x16x32_bf16 v[68:71], v[148:151], v[180:183], v[68:71]
    s_add_u32 s11, s11, 128
    v_mfma_f32_16x16x32_bf16 v[72:75], v[152:155], v[180:183], v[72:75]
    v_mfma_f32_16x16x32_bf16 v[76:79], v[148:151], v[184:187], v[76:79]
    v_mfma_f32_16x16x32_bf16 v[80:83], v[152:155], v[184:187], v[80:83]
    s_add_u32 m0, s9, 110592
    v_mfma_f32_16x16x32_bf16 v[84:87], v[148:151], v[188:191], v[84:87]
    v_mfma_f32_16x16x32_bf16 v[88:91], v[152:155], v[188:191], v[88:91]
    buffer_load_dwordx4 v1, s[16:19], s11 offen offset:0 lds
    v_mfma_f32_16x16x32_bf16 v[92:95], v[148:151], v[192:195], v[92:95]
    v_mfma_f32_16x16x32_bf16 v[96:99], v[152:155], v[192:195], v[96:99]
    s_waitcnt lgkmcnt(0)
    v_mfma_f32_16x16x32_bf16 v[20:23], v[100:103], v[108:111], v[20:23]
    ds_read_b128 v[148:151], v11 offset:36864
    s_lshl_b32 s12, s8, 2
    v_mfma_f32_16x16x32_bf16 v[24:27], v[104:107], v[108:111], v[24:27]
    ds_read_b128 v[156:159], v15 offset:36864
    buffer_load_dwordx4 v2, s[16:19], s11 offen offset:1024 lds
    v_mfma_f32_16x16x32_bf16 v[28:31], v[100:103], v[112:115], v[28:31]
    ds_read_b128 v[152:155], v11 offset:38912
    s_sub_u32 s12, s4, s12
    v_mfma_f32_16x16x32_bf16 v[32:35], v[104:107], v[112:115], v[32:35]
    ds_read_b128 v[160:163], v15 offset:46080
    s_sub_u32 s12, s12, 1
    v_mfma_f32_16x16x32_bf16 v[36:39], v[100:103], v[116:119], v[36:39]
    ds_read_b128 v[164:167], v15 offset:37888
    buffer_load_dwordx4 v3, s[16:19], s11 offen offset:2048 lds
    v_mfma_f32_16x16x32_bf16 v[40:43], v[104:107], v[116:119], v[40:43]
    ds_read_b128 v[168:171], v15 offset:47104
    v_sub_u32 v246, s12, v251
    v_mfma_f32_16x16x32_bf16 v[44:47], v[100:103], v[120:123], v[44:47]
    ds_read_b128 v[172:175], v15 offset:38912
    v_cmp_le_i32 s[14:15], 0, v246
    v_mfma_f32_16x16x32_bf16 v[48:51], v[104:107], v[120:123], v[48:51]
    ds_read_b128 v[176:179], v15 offset:48128
    buffer_load_dwordx4 v4, s[16:19], s11 offen offset:3072 lds
    v_mfma_f32_16x16x32_bf16 v[52:55], v[100:103], v[124:127], v[52:55]
    ds_read_b128 v[180:183], v15 offset:39936
    v_max_i32_e64 v246, 0, v246
    v_mfma_f32_16x16x32_bf16 v[56:59], v[104:107], v[124:127], v[56:59]
    ds_read_b128 v[184:187], v15 offset:49152
    v_and_b32_e64 v247, 3, v246
    v_mfma_f32_16x16x32_bf16 v[60:63], v[100:103], v[128:131], v[60:63]
    ds_read_b128 v[188:191], v15 offset:40960
    s_add_u32 m0, s9, 114688
    v_mfma_f32_16x16x32_bf16 v[64:67], v[104:107], v[128:131], v[64:67]
    ds_read_b128 v[192:195], v15 offset:50176
    v_lshrrev_b32_e64 v246, 2, v246
    v_mfma_f32_16x16x32_bf16 v[68:71], v[100:103], v[132:135], v[68:71]
    v_cmp_eq_u32_e64 vcc, 0, v247
    v_mfma_f32_16x16x32_bf16 v[72:75], v[104:107], v[132:135], v[72:75]
    buffer_load_dwordx4 v5, s[20:23], s11 offen offset:0 lds
    v_add_u32_e64 v226, 9, v247
    v_mfma_f32_16x16x32_bf16 v[76:79], v[100:103], v[136:139], v[76:79]
    v_mul_u32_u24 v226, 640, v226
    v_mfma_f32_16x16x32_bf16 v[80:83], v[104:107], v[136:139], v[80:83]
    v_mfma_f32_16x16x32_bf16 v[84:87], v[100:103], v[140:143], v[84:87]
    buffer_load_dwordx4 v6, s[20:23], s11 offen offset:1024 lds
    v_add_u32_e64 v226, v250, v226
    v_mfma_f32_16x16x32_bf16 v[88:91], v[104:107], v[140:143], v[88:91]
    v_cndmask_b32_e64 v226, v226, v250, vcc
    v_mfma_f32_16x16x32_bf16 v[92:95], v[100:103], v[144:147], v[92:95]
    v_mfma_f32_16x16x32_bf16 v[96:99], v[104:107], v[144:147], v[96:99]
    s_waitcnt vmcnt(6) lgkmcnt(0)
    s_barrier
    v_mfma_f32_16x16x32_bf16 v[20:23], v[148:151], v[156:159], v[20:23]
    ds_read_b128 v[100:103], v12 offset:0
    v_cmp_eq_u32_e64 vcc, 0, v246
    v_mfma_f32_16x16x32_bf16 v[24:27], v[152:155], v[156:159], v[24:27]
    ds_read_b128 v[108:111], v16 offset:0
    buffer_load_dwordx4 v7, s[20:23], s11 offen offset:2048 lds
    v_mfma_f32_16x16x32_bf16 v[28:31], v[148:151], v[160:163], v[28:31]
    ds_read_b128 v[104:107], v12 offset:2048
    v_add_u32_e64 v227, 12, v246
    v_mfma_f32_16x16x32_bf16 v[32:35], v[152:155], v[160:163], v[32:35]
    ds_read_b128 v[112:115], v16 offset:9216
    buffer_load_dwordx4 v8, s[20:23], s11 offen offset:3072 lds
    v_mfma_f32_16x16x32_bf16 v[36:39], v[148:151], v[164:167], v[36:39]
    ds_read_b128 v[116:119], v16 offset:1024
    v_mul_u32_u24 v227, 640, v227
    v_mfma_f32_16x16x32_bf16 v[40:43], v[152:155], v[164:167], v[40:43]
    ds_read_b128 v[120:123], v16 offset:10240
    s_add_u32 m0, s9, 118784
    v_mfma_f32_16x16x32_bf16 v[44:47], v[148:151], v[168:171], v[44:47]
    ds_read_b128 v[124:127], v16 offset:2048
    v_add_u32_e64 v227, v250, v227
    v_mfma_f32_16x16x32_bf16 v[48:51], v[152:155], v[168:171], v[48:51]
    ds_read_b128 v[128:131], v16 offset:11264
    v_cndmask_b32_e64 v227, v227, v250, vcc
    v_mfma_f32_16x16x32_bf16 v[52:55], v[148:151], v[172:175], v[52:55]
    ds_read_b128 v[132:135], v16 offset:3072
    buffer_load_dwordx4 v9, s[20:23], s11 offen offset:0 lds
    v_mfma_f32_16x16x32_bf16 v[56:59], v[152:155], v[172:175], v[56:59]
    ds_read_b128 v[136:139], v16 offset:12288
    v_cmp_eq_u32_e64 vcc, 0, v251
    v_mfma_f32_16x16x32_bf16 v[60:63], v[148:151], v[176:179], v[60:63]
    ds_read_b128 v[140:143], v16 offset:4096
    s_add_u32 s11, s11, 128
    v_mfma_f32_16x16x32_bf16 v[64:67], v[152:155], v[176:179], v[64:67]
    ds_read_b128 v[144:147], v16 offset:13312
    v_add_u32_e64 v228, 3, v251
    v_mfma_f32_16x16x32_bf16 v[68:71], v[148:151], v[180:183], v[68:71]
    s_add_u32 m0, s9, 0
    v_mul_u32_u24 v228, 640, v228
    v_mfma_f32_16x16x32_bf16 v[72:75], v[152:155], v[180:183], v[72:75]
    v_add_u32 v228, v250, v228
    v_mfma_f32_16x16x32_bf16 v[76:79], v[148:151], v[184:187], v[76:79]
    v_mfma_f32_16x16x32_bf16 v[80:83], v[152:155], v[184:187], v[80:83]
    buffer_load_dwordx4 v1, s[16:19], s11 offen offset:0 lds
    v_cndmask_b32_e64 v228, v228, v250, vcc
    v_mfma_f32_16x16x32_bf16 v[84:87], v[148:151], v[188:191], v[84:87]
    v_mfma_f32_16x16x32_bf16 v[88:91], v[152:155], v[188:191], v[88:91]
    buffer_load_dwordx4 v2, s[16:19], s11 offen offset:1024 lds
    v_mov_b32_e64 v246, s8
    v_mfma_f32_16x16x32_bf16 v[92:95], v[148:151], v[192:195], v[92:95]
    v_mfma_f32_16x16x32_bf16 v[96:99], v[152:155], v[192:195], v[96:99]
    s_waitcnt lgkmcnt(0)
    v_mfma_f32_16x16x32_bf16 v[20:23], v[100:103], v[108:111], v[20:23]
    ds_read_b128 v[148:151], v13 offset:0
    v_cmp_eq_u32 vcc, 0, v246
    v_mfma_f32_16x16x32_bf16 v[24:27], v[104:107], v[108:111], v[24:27]
    ds_read_b128 v[156:159], v17 offset:0
    buffer_load_dwordx4 v3, s[16:19], s11 offen offset:2048 lds
    v_mfma_f32_16x16x32_bf16 v[28:31], v[100:103], v[112:115], v[28:31]
    ds_read_b128 v[152:155], v13 offset:2048
    v_add_u32_e64 v229, 6, v246
    v_mfma_f32_16x16x32_bf16 v[32:35], v[104:107], v[112:115], v[32:35]
    ds_read_b128 v[160:163], v17 offset:9216
    v_mfma_f32_16x16x32_bf16 v[36:39], v[100:103], v[116:119], v[36:39]
    ds_read_b128 v[164:167], v17 offset:1024
    buffer_load_dwordx4 v4, s[16:19], s11 offen offset:3072 lds
    v_mfma_f32_16x16x32_bf16 v[40:43], v[104:107], v[116:119], v[40:43]
    ds_read_b128 v[168:171], v17 offset:10240
    v_mul_u32_u24 v229, 640, v229
    v_mfma_f32_16x16x32_bf16 v[44:47], v[100:103], v[120:123], v[44:47]
    ds_read_b128 v[172:175], v17 offset:2048
    v_mfma_f32_16x16x32_bf16 v[48:51], v[104:107], v[120:123], v[48:51]
    ds_read_b128 v[176:179], v17 offset:11264
    s_add_u32 m0, s9, 4096
    v_mfma_f32_16x16x32_bf16 v[52:55], v[100:103], v[124:127], v[52:55]
    ds_read_b128 v[180:183], v17 offset:3072
    v_add_u32_e64 v229, v250, v229
    v_mfma_f32_16x16x32_bf16 v[56:59], v[104:107], v[124:127], v[56:59]
    ds_read_b128 v[184:187], v17 offset:12288
    v_cndmask_b32_e64 v229, v229, v250, vcc
    v_mfma_f32_16x16x32_bf16 v[60:63], v[100:103], v[128:131], v[60:63]
    ds_read_b128 v[188:191], v17 offset:4096
    buffer_load_dwordx4 v5, s[20:23], s11 offen offset:0 lds
    v_mfma_f32_16x16x32_bf16 v[64:67], v[104:107], v[128:131], v[64:67]
    ds_read_b128 v[192:195], v17 offset:13312
    v_and_b32_e64 v230, 1, v251
    v_mfma_f32_16x16x32_bf16 v[68:71], v[100:103], v[132:135], v[68:71]
    v_mfma_f32_16x16x32_bf16 v[72:75], v[104:107], v[132:135], v[72:75]
    buffer_load_dwordx4 v6, s[20:23], s11 offen offset:1024 lds
    v_mfma_f32_16x16x32_bf16 v[76:79], v[100:103], v[136:139], v[76:79]
    v_mul_u32_u24 v230, 2560, v230
    v_mfma_f32_16x16x32_bf16 v[80:83], v[104:107], v[136:139], v[80:83]
    v_mfma_f32_16x16x32_bf16 v[84:87], v[100:103], v[140:143], v[84:87]
    buffer_load_dwordx4 v7, s[20:23], s11 offen offset:2048 lds
    v_add_u32_e64 v230, v250, v230
    v_mfma_f32_16x16x32_bf16 v[88:91], v[104:107], v[140:143], v[88:91]
    v_mfma_f32_16x16x32_bf16 v[92:95], v[100:103], v[144:147], v[92:95]
    v_mfma_f32_16x16x32_bf16 v[96:99], v[104:107], v[144:147], v[96:99]
    s_waitcnt vmcnt(7) lgkmcnt(0)
    s_barrier
    v_mfma_f32_16x16x32_bf16 v[20:23], v[148:151], v[156:159], v[20:23]
    ds_read_b128 v[100:103], v12 offset:36864
    v_sub_u32_e64 v246, 3, v251
    v_mfma_f32_16x16x32_bf16 v[24:27], v[152:155], v[156:159], v[24:27]
    ds_read_b128 v[108:111], v16 offset:36864
    buffer_load_dwordx4 v8, s[20:23], s11 offen offset:3072 lds
    v_mfma_f32_16x16x32_bf16 v[28:31], v[148:151], v[160:163], v[28:31]
    ds_read_b128 v[104:107], v12 offset:38912
    v_cmp_eq_u32_e64 vcc, 0, v246
    v_mfma_f32_16x16x32_bf16 v[32:35], v[152:155], v[160:163], v[32:35]
    ds_read_b128 v[112:115], v16 offset:46080
    s_add_u32 m0, s9, 8192
    v_mfma_f32_16x16x32_bf16 v[36:39], v[148:151], v[164:167], v[36:39]
    ds_read_b128 v[116:119], v16 offset:37888
    v_add_u32_e64 v248, 3, v246
    v_mfma_f32_16x16x32_bf16 v[40:43], v[152:155], v[164:167], v[40:43]
    ds_read_b128 v[120:123], v16 offset:47104
    buffer_load_dwordx4 v9, s[20:23], s11 offen offset:0 lds
    v_mfma_f32_16x16x32_bf16 v[44:47], v[148:151], v[168:171], v[44:47]
    ds_read_b128 v[124:127], v16 offset:38912
    v_mul_u32_u24 v248, 640, v248
    v_mfma_f32_16x16x32_bf16 v[48:51], v[152:155], v[168:171], v[48:51]
    ds_read_b128 v[128:131], v16 offset:48128
    v_add_u32_e64 v248, v250, v248
    v_mfma_f32_16x16x32_bf16 v[52:55], v[148:151], v[172:175], v[52:55]
    ds_read_b128 v[132:135], v16 offset:39936
    s_add_u32 s11, s11, 128
    v_mfma_f32_16x16x32_bf16 v[56:59], v[152:155], v[172:175], v[56:59]
    ds_read_b128 v[136:139], v16 offset:49152
    v_cndmask_b32_e64 v248, v248, v250, vcc
    v_mfma_f32_16x16x32_bf16 v[60:63], v[148:151], v[176:179], v[60:63]
    ds_read_b128 v[140:143], v16 offset:40960
    s_add_u32 m0, s9, 36864
    v_mfma_f32_16x16x32_bf16 v[64:67], v[152:155], v[176:179], v[64:67]
    ds_read_b128 v[144:147], v16 offset:50176
    ds_read_b64 v[216:217], v248 offset:0
    v_mfma_f32_16x16x32_bf16 v[68:71], v[148:151], v[180:183], v[68:71]
    buffer_load_dwordx4 v1, s[16:19], s11 offen offset:0 lds
    ds_read_b64 v[218:219], v248 offset:128
    v_mfma_f32_16x16x32_bf16 v[72:75], v[152:155], v[180:183], v[72:75]
    ds_read_b64 v[220:221], v248 offset:256
    v_mfma_f32_16x16x32_bf16 v[76:79], v[148:151], v[184:187], v[76:79]
    v_mfma_f32_16x16x32_bf16 v[80:83], v[152:155], v[184:187], v[80:83]
    buffer_load_dwordx4 v2, s[16:19], s11 offen offset:1024 lds
    ds_read_b64 v[222:223], v248 offset:384
    v_mfma_f32_16x16x32_bf16 v[84:87], v[148:151], v[188:191], v[84:87]
    v_mfma_f32_16x16x32_bf16 v[88:91], v[152:155], v[188:191], v[88:91]
    buffer_load_dwordx4 v3, s[16:19], s11 offen offset:2048 lds
    ds_read_b64 v[224:225], v248 offset:512
    v_mfma_f32_16x16x32_bf16 v[92:95], v[148:151], v[192:195], v[92:95]
    v_mfma_f32_16x16x32_bf16 v[96:99], v[152:155], v[192:195], v[96:99]
    s_waitcnt lgkmcnt(0)
    v_mfma_f32_16x16x32_bf16 v[20:23], v[100:103], v[108:111], v[20:23]
    ds_read_b128 v[148:151], v13 offset:36864
    ds_read_b64 v[206:207], v250 offset:1280
    v_mfma_f32_16x16x32_bf16 v[24:27], v[104:107], v[108:111], v[24:27]
    ds_read_b128 v[156:159], v17 offset:36864
    buffer_load_dwordx4 v4, s[16:19], s11 offen offset:3072 lds
    v_mfma_f32_16x16x32_bf16 v[28:31], v[100:103], v[112:115], v[28:31]
    ds_read_b128 v[152:155], v13 offset:38912
    ds_read_b64 v[208:209], v250 offset:1408
    v_mfma_f32_16x16x32_bf16 v[32:35], v[104:107], v[112:115], v[32:35]
    ds_read_b128 v[160:163], v17 offset:46080
    ds_read_b64 v[210:211], v250 offset:1536
    v_mfma_f32_16x16x32_bf16 v[36:39], v[100:103], v[116:119], v[36:39]
    ds_read_b128 v[164:167], v17 offset:37888
    s_add_u32 m0, s9, 40960
    v_mfma_f32_16x16x32_bf16 v[40:43], v[104:107], v[116:119], v[40:43]
    ds_read_b128 v[168:171], v17 offset:47104
    ds_read_b64 v[212:213], v250 offset:1664
    v_mfma_f32_16x16x32_bf16 v[44:47], v[100:103], v[120:123], v[44:47]
    ds_read_b128 v[172:175], v17 offset:38912
    v_mfma_f32_16x16x32_bf16 v[48:51], v[104:107], v[120:123], v[48:51]
    ds_read_b128 v[176:179], v17 offset:48128
    buffer_load_dwordx4 v5, s[20:23], s11 offen offset:0 lds
    v_mfma_f32_16x16x32_bf16 v[52:55], v[100:103], v[124:127], v[52:55]
    ds_read_b128 v[180:183], v17 offset:39936
    ds_read_b64 v[214:215], v250 offset:1792
    v_mfma_f32_16x16x32_bf16 v[56:59], v[104:107], v[124:127], v[56:59]
    ds_read_b128 v[184:187], v17 offset:49152
    ds_read_b64 v[196:197], v250 offset:640
    v_mfma_f32_16x16x32_bf16 v[60:63], v[100:103], v[128:131], v[60:63]
    ds_read_b128 v[188:191], v17 offset:40960
    buffer_load_dwordx4 v6, s[20:23], s11 offen offset:1024 lds
    v_mfma_f32_16x16x32_bf16 v[64:67], v[104:107], v[128:131], v[64:67]
    ds_read_b128 v[192:195], v17 offset:50176
    ds_read_b64 v[198:199], v250 offset:768
    v_mfma_f32_16x16x32_bf16 v[68:71], v[100:103], v[132:135], v[68:71]
    v_mfma_f32_16x16x32_bf16 v[72:75], v[104:107], v[132:135], v[72:75]
    buffer_load_dwordx4 v7, s[20:23], s11 offen offset:2048 lds
    ds_read_b64 v[200:201], v250 offset:896
    v_mfma_f32_16x16x32_bf16 v[76:79], v[100:103], v[136:139], v[76:79]
    v_mfma_f32_16x16x32_bf16 v[80:83], v[104:107], v[136:139], v[80:83]
    ds_read_b64 v[202:203], v250 offset:1024
    v_mfma_f32_16x16x32_bf16 v[84:87], v[100:103], v[140:143], v[84:87]
    buffer_load_dwordx4 v8, s[20:23], s11 offen offset:3072 lds
    v_mfma_f32_16x16x32_bf16 v[88:91], v[104:107], v[140:143], v[88:91]
    ds_read_b64 v[204:205], v250 offset:1152
    v_mfma_f32_16x16x32_bf16 v[92:95], v[100:103], v[144:147], v[92:95]
    v_mfma_f32_16x16x32_bf16 v[96:99], v[104:107], v[144:147], v[96:99]
    s_waitcnt vmcnt(8) lgkmcnt(0)
    s_barrier
    v_mfma_f32_16x16x32_bf16 v[20:23], v[148:151], v[156:159], v[20:23]
    ds_read_b128 v[100:103], v10 offset:0
    v_mfma_f32_16x16x32_bf16 v[24:27], v[152:155], v[156:159], v[24:27]
    ds_read_b128 v[108:111], v14 offset:0
    s_add_u32 m0, s9, 45056
    v_mfma_f32_16x16x32_bf16 v[28:31], v[148:151], v[160:163], v[28:31]
    ds_read_b128 v[104:107], v10 offset:2048
    v_mfma_f32_16x16x32_bf16 v[32:35], v[152:155], v[160:163], v[32:35]
    ds_read_b128 v[112:115], v14 offset:9216
    buffer_load_dwordx4 v9, s[20:23], s11 offen offset:0 lds
    v_mfma_f32_16x16x32_bf16 v[36:39], v[148:151], v[164:167], v[36:39]
    ds_read_b128 v[116:119], v14 offset:1024
    v_mfma_f32_16x16x32_bf16 v[40:43], v[152:155], v[164:167], v[40:43]
    ds_read_b128 v[120:123], v14 offset:10240
    s_add_u32 s11, s11, 128
    v_mfma_f32_16x16x32_bf16 v[44:47], v[148:151], v[168:171], v[44:47]
    ds_read_b128 v[124:127], v14 offset:2048
    v_mfma_f32_16x16x32_bf16 v[48:51], v[152:155], v[168:171], v[48:51]
    ds_read_b128 v[128:131], v14 offset:11264
    v_mfma_f32_16x16x32_bf16 v[52:55], v[148:151], v[172:175], v[52:55]
    ds_read_b128 v[132:135], v14 offset:3072
    s_add_u32 m0, s9, 73728
    v_mfma_f32_16x16x32_bf16 v[56:59], v[152:155], v[172:175], v[56:59]
    ds_read_b128 v[136:139], v14 offset:12288
    v_mfma_f32_16x16x32_bf16 v[60:63], v[148:151], v[176:179], v[60:63]
    ds_read_b128 v[140:143], v14 offset:4096
    buffer_load_dwordx4 v1, s[16:19], s11 offen offset:0 lds
    v_mfma_f32_16x16x32_bf16 v[64:67], v[152:155], v[176:179], v[64:67]
    ds_read_b128 v[144:147], v14 offset:13312
    v_mfma_f32_16x16x32_bf16 v[68:71], v[148:151], v[180:183], v[68:71]
    buffer_load_dwordx4 v2, s[16:19], s11 offen offset:1024 lds
    v_mfma_f32_16x16x32_bf16 v[72:75], v[152:155], v[180:183], v[72:75]
    v_mfma_f32_16x16x32_bf16 v[76:79], v[148:151], v[184:187], v[76:79]
    v_mfma_f32_16x16x32_bf16 v[80:83], v[152:155], v[184:187], v[80:83]
    buffer_load_dwordx4 v3, s[16:19], s11 offen offset:2048 lds
    v_mfma_f32_16x16x32_bf16 v[84:87], v[148:151], v[188:191], v[84:87]
    v_mfma_f32_16x16x32_bf16 v[88:91], v[152:155], v[188:191], v[88:91]
    buffer_load_dwordx4 v4, s[16:19], s11 offen offset:3072 lds
    v_mfma_f32_16x16x32_bf16 v[92:95], v[148:151], v[192:195], v[92:95]
    v_mfma_f32_16x16x32_bf16 v[96:99], v[152:155], v[192:195], v[96:99]
    s_waitcnt lgkmcnt(0)
    v_mfma_f32_16x16x32_bf16 v[20:23], v[100:103], v[108:111], v[20:23]
    ds_read_b128 v[148:151], v11 offset:0
    v_bfe_u32 v232, v0, 2, 2
    v_mfma_f32_16x16x32_bf16 v[24:27], v[104:107], v[108:111], v[24:27]
    ds_read_b128 v[156:159], v15 offset:0
    s_add_u32 m0, s9, 77824
    v_mfma_f32_16x16x32_bf16 v[28:31], v[100:103], v[112:115], v[28:31]
    ds_read_b128 v[152:155], v11 offset:2048
    v_bfe_u32 v233, v0, 4, 1
    v_mfma_f32_16x16x32_bf16 v[32:35], v[104:107], v[112:115], v[32:35]
    ds_read_b128 v[160:163], v15 offset:9216
    buffer_load_dwordx4 v5, s[20:23], s11 offen offset:0 lds
    v_mfma_f32_16x16x32_bf16 v[36:39], v[100:103], v[116:119], v[36:39]
    ds_read_b128 v[164:167], v15 offset:1024
    v_lshl_add_u32 v232, v233, 3, v232
    v_mfma_f32_16x16x32_bf16 v[40:43], v[104:107], v[116:119], v[40:43]
    ds_read_b128 v[168:171], v15 offset:10240
    v_bfe_u32 v233, v0, 1, 1
    v_mfma_f32_16x16x32_bf16 v[44:47], v[100:103], v[120:123], v[44:47]
    ds_read_b128 v[172:175], v15 offset:2048
    buffer_load_dwordx4 v6, s[20:23], s11 offen offset:1024 lds
    v_mfma_f32_16x16x32_bf16 v[48:51], v[104:107], v[120:123], v[48:51]
    ds_read_b128 v[176:179], v15 offset:11264
    v_lshlrev_b32_e64 v234, 2, v233
    v_mfma_f32_16x16x32_bf16 v[52:55], v[100:103], v[124:127], v[52:55]
    ds_read_b128 v[180:183], v15 offset:3072
    v_xor_b32_e64 v232, v232, v234
    v_mfma_f32_16x16x32_bf16 v[56:59], v[104:107], v[124:127], v[56:59]
    ds_read_b128 v[184:187], v15 offset:12288
    buffer_load_dwordx4 v7, s[20:23], s11 offen offset:2048 lds
    v_mfma_f32_16x16x32_bf16 v[60:63], v[100:103], v[128:131], v[60:63]
    ds_read_b128 v[188:191], v15 offset:4096
    v_lshlrev_b32_e64 v232, 4, v232
    v_mfma_f32_16x16x32_bf16 v[64:67], v[104:107], v[128:131], v[64:67]
    ds_read_b128 v[192:195], v15 offset:13312
    buffer_load_dwordx4 v8, s[20:23], s11 offen offset:3072 lds
    v_mfma_f32_16x16x32_bf16 v[68:71], v[100:103], v[132:135], v[68:71]
    v_lshl_add_u32 v232, v233, 8, v232
    v_and_b32_e64 v233, 1, v0
    v_mfma_f32_16x16x32_bf16 v[72:75], v[104:107], v[132:135], v[72:75]
    v_lshl_add_u32 v232, v233, 3, v232
    v_bfe_u32 v233, v0, 5, 1
    v_mfma_f32_16x16x32_bf16 v[76:79], v[100:103], v[136:139], v[76:79]
    s_add_u32 m0, s9, 81920
    v_lshl_add_u32 v232, v233, 9, v232
    v_mfma_f32_16x16x32_bf16 v[80:83], v[104:107], v[136:139], v[80:83]
    v_add_u32 v244, s9, v232
    v_xor_b32 v245, 64, v244
    v_mfma_f32_16x16x32_bf16 v[84:87], v[100:103], v[140:143], v[84:87]
    v_and_b32 v232, 31, v0
    v_lshlrev_b32 v232, 4, v232
    v_mfma_f32_16x16x32_bf16 v[88:91], v[104:107], v[140:143], v[88:91]
    buffer_load_dwordx4 v9, s[20:23], s11 offen offset:0 lds
    v_mul_u32_u24 v233, 10240, v233
    v_mfma_f32_16x16x32_bf16 v[92:95], v[100:103], v[144:147], v[92:95]
    v_add_u32_e64 v243, v233, v232
    v_mfma_f32_16x16x32_bf16 v[96:99], v[104:107], v[144:147], v[96:99]
    s_waitcnt vmcnt(9) lgkmcnt(0)
    s_barrier
    v_mfma_f32_16x16x32_bf16 v[20:23], v[148:151], v[156:159], v[20:23]
    ds_read_b128 v[100:103], v10 offset:36864
    v_mfma_f32_16x16x32_bf16 v[24:27], v[152:155], v[156:159], v[24:27]
    ds_read_b128 v[108:111], v14 offset:36864
    s_add_u32 s11, s11, 128
    v_mfma_f32_16x16x32_bf16 v[28:31], v[148:151], v[160:163], v[28:31]
    ds_read_b128 v[104:107], v10 offset:38912
    v_mfma_f32_16x16x32_bf16 v[32:35], v[152:155], v[160:163], v[32:35]
    ds_read_b128 v[112:115], v14 offset:46080
    s_add_u32 m0, s9, 110592
    v_mfma_f32_16x16x32_bf16 v[36:39], v[148:151], v[164:167], v[36:39]
    ds_read_b128 v[116:119], v14 offset:37888
    v_mfma_f32_16x16x32_bf16 v[40:43], v[152:155], v[164:167], v[40:43]
    ds_read_b128 v[120:123], v14 offset:47104
    buffer_load_dwordx4 v1, s[16:19], s11 offen offset:0 lds
    v_mfma_f32_16x16x32_bf16 v[44:47], v[148:151], v[168:171], v[44:47]
    ds_read_b128 v[124:127], v14 offset:38912
    v_mfma_f32_16x16x32_bf16 v[48:51], v[152:155], v[168:171], v[48:51]
    ds_read_b128 v[128:131], v14 offset:48128
    v_mfma_f32_16x16x32_bf16 v[52:55], v[148:151], v[172:175], v[52:55]
    ds_read_b128 v[132:135], v14 offset:39936
    buffer_load_dwordx4 v2, s[16:19], s11 offen offset:1024 lds
    v_mfma_f32_16x16x32_bf16 v[56:59], v[152:155], v[172:175], v[56:59]
    ds_read_b128 v[136:139], v14 offset:49152
    v_mfma_f32_16x16x32_bf16 v[60:63], v[148:151], v[176:179], v[60:63]
    ds_read_b128 v[140:143], v14 offset:40960
    buffer_load_dwordx4 v3, s[16:19], s11 offen offset:2048 lds
    v_mfma_f32_16x16x32_bf16 v[64:67], v[152:155], v[176:179], v[64:67]
    ds_read_b128 v[144:147], v14 offset:50176
    v_mfma_f32_16x16x32_bf16 v[68:71], v[148:151], v[180:183], v[68:71]
    buffer_load_dwordx4 v4, s[16:19], s11 offen offset:3072 lds
    v_mfma_f32_16x16x32_bf16 v[72:75], v[152:155], v[180:183], v[72:75]
    v_mfma_f32_16x16x32_bf16 v[76:79], v[148:151], v[184:187], v[76:79]
    v_mfma_f32_16x16x32_bf16 v[80:83], v[152:155], v[184:187], v[80:83]
    s_add_u32 m0, s9, 114688
    v_mfma_f32_16x16x32_bf16 v[84:87], v[148:151], v[188:191], v[84:87]
    v_mfma_f32_16x16x32_bf16 v[88:91], v[152:155], v[188:191], v[88:91]
    buffer_load_dwordx4 v5, s[20:23], s11 offen offset:0 lds
    v_mfma_f32_16x16x32_bf16 v[92:95], v[148:151], v[192:195], v[92:95]
    v_mfma_f32_16x16x32_bf16 v[96:99], v[152:155], v[192:195], v[96:99]
    s_waitcnt lgkmcnt(0)
    v_mfma_f32_16x16x32_bf16 v[20:23], v[100:103], v[108:111], v[20:23]
    ds_read_b128 v[148:151], v11 offset:36864
    v_mfma_f32_16x16x32_bf16 v[24:27], v[104:107], v[108:111], v[24:27]
    ds_read_b128 v[156:159], v15 offset:36864
    buffer_load_dwordx4 v6, s[20:23], s11 offen offset:1024 lds
    v_mfma_f32_16x16x32_bf16 v[28:31], v[100:103], v[112:115], v[28:31]
    ds_read_b128 v[152:155], v11 offset:38912
    v_mfma_f32_16x16x32_bf16 v[32:35], v[104:107], v[112:115], v[32:35]
    ds_read_b128 v[160:163], v15 offset:46080
    buffer_load_dwordx4 v7, s[20:23], s11 offen offset:2048 lds
    v_mfma_f32_16x16x32_bf16 v[36:39], v[100:103], v[116:119], v[36:39]
    ds_read_b128 v[164:167], v15 offset:37888
    v_mfma_f32_16x16x32_bf16 v[40:43], v[104:107], v[116:119], v[40:43]
    ds_read_b128 v[168:171], v15 offset:47104
    buffer_load_dwordx4 v8, s[20:23], s11 offen offset:3072 lds
    v_mfma_f32_16x16x32_bf16 v[44:47], v[100:103], v[120:123], v[44:47]
    ds_read_b128 v[172:175], v15 offset:38912
    v_mfma_f32_16x16x32_bf16 v[48:51], v[104:107], v[120:123], v[48:51]
    ds_read_b128 v[176:179], v15 offset:48128
    v_mfma_f32_16x16x32_bf16 v[52:55], v[100:103], v[124:127], v[52:55]
    ds_read_b128 v[180:183], v15 offset:39936
    s_add_u32 m0, s9, 118784
    v_mfma_f32_16x16x32_bf16 v[56:59], v[104:107], v[124:127], v[56:59]
    ds_read_b128 v[184:187], v15 offset:49152
    v_mfma_f32_16x16x32_bf16 v[60:63], v[100:103], v[128:131], v[60:63]
    ds_read_b128 v[188:191], v15 offset:40960
    buffer_load_dwordx4 v9, s[20:23], s11 offen offset:0 lds
    v_mfma_f32_16x16x32_bf16 v[64:67], v[104:107], v[128:131], v[64:67]
    ds_read_b128 v[192:195], v15 offset:50176
    v_mfma_f32_16x16x32_bf16 v[68:71], v[100:103], v[132:135], v[68:71]
    s_add_u32 s11, s11, 128
    v_mfma_f32_16x16x32_bf16 v[72:75], v[104:107], v[132:135], v[72:75]
    v_mfma_f32_16x16x32_bf16 v[76:79], v[100:103], v[136:139], v[76:79]
    v_mfma_f32_16x16x32_bf16 v[80:83], v[104:107], v[136:139], v[80:83]
    s_add_u32 m0, s9, 0
    v_mfma_f32_16x16x32_bf16 v[84:87], v[100:103], v[140:143], v[84:87]
    v_mfma_f32_16x16x32_bf16 v[88:91], v[104:107], v[140:143], v[88:91]
    buffer_load_dwordx4 v1, s[16:19], s11 offen offset:0 lds
    v_mfma_f32_16x16x32_bf16 v[92:95], v[100:103], v[144:147], v[92:95]
    v_mfma_f32_16x16x32_bf16 v[96:99], v[104:107], v[144:147], v[96:99]
    s_waitcnt vmcnt(10) lgkmcnt(0)
    s_barrier
    v_mfma_f32_16x16x32_bf16 v[20:23], v[148:151], v[156:159], v[20:23]
    ds_read_b128 v[100:103], v12 offset:0
    v_mfma_f32_16x16x32_bf16 v[24:27], v[152:155], v[156:159], v[24:27]
    ds_read_b128 v[108:111], v16 offset:0
    buffer_load_dwordx4 v2, s[16:19], s11 offen offset:1024 lds
    v_mfma_f32_16x16x32_bf16 v[28:31], v[148:151], v[160:163], v[28:31]
    ds_read_b128 v[104:107], v12 offset:2048
    v_mfma_f32_16x16x32_bf16 v[32:35], v[152:155], v[160:163], v[32:35]
    ds_read_b128 v[112:115], v16 offset:9216
    v_mfma_f32_16x16x32_bf16 v[36:39], v[148:151], v[164:167], v[36:39]
    ds_read_b128 v[116:119], v16 offset:1024
    buffer_load_dwordx4 v3, s[16:19], s11 offen offset:2048 lds
    v_mfma_f32_16x16x32_bf16 v[40:43], v[152:155], v[164:167], v[40:43]
    ds_read_b128 v[120:123], v16 offset:10240
    v_mfma_f32_16x16x32_bf16 v[44:47], v[148:151], v[168:171], v[44:47]
    ds_read_b128 v[124:127], v16 offset:2048
    v_mfma_f32_16x16x32_bf16 v[48:51], v[152:155], v[168:171], v[48:51]
    ds_read_b128 v[128:131], v16 offset:11264
    buffer_load_dwordx4 v4, s[16:19], s11 offen offset:3072 lds
    v_mfma_f32_16x16x32_bf16 v[52:55], v[148:151], v[172:175], v[52:55]
    ds_read_b128 v[132:135], v16 offset:3072
    v_mfma_f32_16x16x32_bf16 v[56:59], v[152:155], v[172:175], v[56:59]
    ds_read_b128 v[136:139], v16 offset:12288
    v_mfma_f32_16x16x32_bf16 v[60:63], v[148:151], v[176:179], v[60:63]
    ds_read_b128 v[140:143], v16 offset:4096
    s_add_u32 m0, s9, 4096
    v_mfma_f32_16x16x32_bf16 v[64:67], v[152:155], v[176:179], v[64:67]
    ds_read_b128 v[144:147], v16 offset:13312
    v_mfma_f32_16x16x32_bf16 v[68:71], v[148:151], v[180:183], v[68:71]
    v_mfma_f32_16x16x32_bf16 v[72:75], v[152:155], v[180:183], v[72:75]
    buffer_load_dwordx4 v5, s[20:23], s11 offen offset:0 lds
    v_mfma_f32_16x16x32_bf16 v[76:79], v[148:151], v[184:187], v[76:79]
    v_mfma_f32_16x16x32_bf16 v[80:83], v[152:155], v[184:187], v[80:83]
    v_mfma_f32_16x16x32_bf16 v[84:87], v[148:151], v[188:191], v[84:87]
    buffer_load_dwordx4 v6, s[20:23], s11 offen offset:1024 lds
    v_mfma_f32_16x16x32_bf16 v[88:91], v[152:155], v[188:191], v[88:91]
    v_mfma_f32_16x16x32_bf16 v[92:95], v[148:151], v[192:195], v[92:95]
    v_mfma_f32_16x16x32_bf16 v[96:99], v[152:155], v[192:195], v[96:99]
    s_waitcnt lgkmcnt(0)
    v_mfma_f32_16x16x32_bf16 v[20:23], v[100:103], v[108:111], v[20:23]
    ds_read_b128 v[148:151], v13 offset:0
    v_mfma_f32_16x16x32_bf16 v[24:27], v[104:107], v[108:111], v[24:27]
    ds_read_b128 v[156:159], v17 offset:0
    buffer_load_dwordx4 v7, s[20:23], s11 offen offset:2048 lds
    v_mfma_f32_16x16x32_bf16 v[28:31], v[100:103], v[112:115], v[28:31]
    ds_read_b128 v[152:155], v13 offset:2048
    v_mfma_f32_16x16x32_bf16 v[32:35], v[104:107], v[112:115], v[32:35]
    ds_read_b128 v[160:163], v17 offset:9216
    buffer_load_dwordx4 v8, s[20:23], s11 offen offset:3072 lds
    v_mfma_f32_16x16x32_bf16 v[36:39], v[100:103], v[116:119], v[36:39]
    ds_read_b128 v[164:167], v17 offset:1024
    v_mfma_f32_16x16x32_bf16 v[40:43], v[104:107], v[116:119], v[40:43]
    ds_read_b128 v[168:171], v17 offset:10240
    s_add_u32 m0, s9, 8192
    v_mfma_f32_16x16x32_bf16 v[44:47], v[100:103], v[120:123], v[44:47]
    ds_read_b128 v[172:175], v17 offset:2048
    v_mfma_f32_16x16x32_bf16 v[48:51], v[104:107], v[120:123], v[48:51]
    ds_read_b128 v[176:179], v17 offset:11264
    v_mfma_f32_16x16x32_bf16 v[52:55], v[100:103], v[124:127], v[52:55]
    ds_read_b128 v[180:183], v17 offset:3072
    buffer_load_dwordx4 v9, s[20:23], s11 offen offset:0 lds
    v_mfma_f32_16x16x32_bf16 v[56:59], v[104:107], v[124:127], v[56:59]
    ds_read_b128 v[184:187], v17 offset:12288
    v_mfma_f32_16x16x32_bf16 v[60:63], v[100:103], v[128:131], v[60:63]
    ds_read_b128 v[188:191], v17 offset:4096
    s_add_u32 s11, s11, 128
    v_mfma_f32_16x16x32_bf16 v[64:67], v[104:107], v[128:131], v[64:67]
    ds_read_b128 v[192:195], v17 offset:13312
    v_mfma_f32_16x16x32_bf16 v[68:71], v[100:103], v[132:135], v[68:71]
    s_add_u32 m0, s9, 36864
    v_mfma_f32_16x16x32_bf16 v[72:75], v[104:107], v[132:135], v[72:75]
    v_mfma_f32_16x16x32_bf16 v[76:79], v[100:103], v[136:139], v[76:79]
    v_mfma_f32_16x16x32_bf16 v[80:83], v[104:107], v[136:139], v[80:83]
    buffer_load_dwordx4 v1, s[16:19], s11 offen offset:0 lds
    v_mfma_f32_16x16x32_bf16 v[84:87], v[100:103], v[140:143], v[84:87]
    v_mfma_f32_16x16x32_bf16 v[88:91], v[104:107], v[140:143], v[88:91]
    buffer_load_dwordx4 v2, s[16:19], s11 offen offset:1024 lds
    v_mfma_f32_16x16x32_bf16 v[92:95], v[100:103], v[144:147], v[92:95]
    v_mfma_f32_16x16x32_bf16 v[96:99], v[104:107], v[144:147], v[96:99]
    s_waitcnt vmcnt(11) lgkmcnt(0)
    s_barrier
    v_mfma_f32_16x16x32_bf16 v[20:23], v[148:151], v[156:159], v[20:23]
    ds_read_b128 v[100:103], v12 offset:36864
    v_mfma_f32_16x16x32_bf16 v[24:27], v[152:155], v[156:159], v[24:27]
    ds_read_b128 v[108:111], v16 offset:36864
    buffer_load_dwordx4 v3, s[16:19], s11 offen offset:2048 lds
    v_mfma_f32_16x16x32_bf16 v[28:31], v[148:151], v[160:163], v[28:31]
    ds_read_b128 v[104:107], v12 offset:38912
    v_mfma_f32_16x16x32_bf16 v[32:35], v[152:155], v[160:163], v[32:35]
    ds_read_b128 v[112:115], v16 offset:46080
    v_mfma_f32_16x16x32_bf16 v[36:39], v[148:151], v[164:167], v[36:39]
    ds_read_b128 v[116:119], v16 offset:37888
    buffer_load_dwordx4 v4, s[16:19], s11 offen offset:3072 lds
    v_mfma_f32_16x16x32_bf16 v[40:43], v[152:155], v[164:167], v[40:43]
    ds_read_b128 v[120:123], v16 offset:47104
    v_mfma_f32_16x16x32_bf16 v[44:47], v[148:151], v[168:171], v[44:47]
    ds_read_b128 v[124:127], v16 offset:38912
    v_mfma_f32_16x16x32_bf16 v[48:51], v[152:155], v[168:171], v[48:51]
    ds_read_b128 v[128:131], v16 offset:48128
    s_add_u32 m0, s9, 40960
    v_mfma_f32_16x16x32_bf16 v[52:55], v[148:151], v[172:175], v[52:55]
    ds_read_b128 v[132:135], v16 offset:39936
    v_mfma_f32_16x16x32_bf16 v[56:59], v[152:155], v[172:175], v[56:59]
    ds_read_b128 v[136:139], v16 offset:49152
    v_mfma_f32_16x16x32_bf16 v[60:63], v[148:151], v[176:179], v[60:63]
    ds_read_b128 v[140:143], v16 offset:40960
    buffer_load_dwordx4 v5, s[20:23], s11 offen offset:0 lds
    v_mfma_f32_16x16x32_bf16 v[64:67], v[152:155], v[176:179], v[64:67]
    ds_read_b128 v[144:147], v16 offset:50176
    v_mfma_f32_16x16x32_bf16 v[68:71], v[148:151], v[180:183], v[68:71]
    v_mfma_f32_16x16x32_bf16 v[72:75], v[152:155], v[180:183], v[72:75]
    buffer_load_dwordx4 v6, s[20:23], s11 offen offset:1024 lds
    v_mfma_f32_16x16x32_bf16 v[76:79], v[148:151], v[184:187], v[76:79]
    v_mfma_f32_16x16x32_bf16 v[80:83], v[152:155], v[184:187], v[80:83]
    v_mfma_f32_16x16x32_bf16 v[84:87], v[148:151], v[188:191], v[84:87]
    buffer_load_dwordx4 v7, s[20:23], s11 offen offset:2048 lds
    v_mfma_f32_16x16x32_bf16 v[88:91], v[152:155], v[188:191], v[88:91]
    v_mfma_f32_16x16x32_bf16 v[92:95], v[148:151], v[192:195], v[92:95]
    v_mfma_f32_16x16x32_bf16 v[96:99], v[152:155], v[192:195], v[96:99]
    s_waitcnt lgkmcnt(0)
    v_mfma_f32_16x16x32_bf16 v[20:23], v[100:103], v[108:111], v[20:23]
    ds_read_b128 v[148:151], v13 offset:36864
    v_mfma_f32_16x16x32_bf16 v[24:27], v[104:107], v[108:111], v[24:27]
    ds_read_b128 v[156:159], v17 offset:36864
    buffer_load_dwordx4 v8, s[20:23], s11 offen offset:3072 lds
    v_mfma_f32_16x16x32_bf16 v[28:31], v[100:103], v[112:115], v[28:31]
    ds_read_b128 v[152:155], v13 offset:38912
    s_add_u32 m0, s9, 45056
    v_mfma_f32_16x16x32_bf16 v[32:35], v[104:107], v[112:115], v[32:35]
    ds_read_b128 v[160:163], v17 offset:46080
    v_mfma_f32_16x16x32_bf16 v[36:39], v[100:103], v[116:119], v[36:39]
    ds_read_b128 v[164:167], v17 offset:37888
    buffer_load_dwordx4 v9, s[20:23], s11 offen offset:0 lds
    v_mfma_f32_16x16x32_bf16 v[40:43], v[104:107], v[116:119], v[40:43]
    ds_read_b128 v[168:171], v17 offset:47104
    v_mfma_f32_16x16x32_bf16 v[44:47], v[100:103], v[120:123], v[44:47]
    ds_read_b128 v[172:175], v17 offset:38912
    s_add_u32 m0, s9, 73728
    v_mfma_f32_16x16x32_bf16 v[48:51], v[104:107], v[120:123], v[48:51]
    ds_read_b128 v[176:179], v17 offset:48128
    v_mfma_f32_16x16x32_bf16 v[52:55], v[100:103], v[124:127], v[52:55]
    ds_read_b128 v[180:183], v17 offset:39936
    s_add_u32 s11, s60, 0
    v_mfma_f32_16x16x32_bf16 v[56:59], v[104:107], v[124:127], v[56:59]
    ds_read_b128 v[184:187], v17 offset:49152
    v_mfma_f32_16x16x32_bf16 v[60:63], v[100:103], v[128:131], v[60:63]
    ds_read_b128 v[188:191], v17 offset:40960
    buffer_load_dwordx4 v18, s[24:27], s11 offen lds
    v_mfma_f32_16x16x32_bf16 v[64:67], v[104:107], v[128:131], v[64:67]
    ds_read_b128 v[192:195], v17 offset:50176
    v_mfma_f32_16x16x32_bf16 v[68:71], v[100:103], v[132:135], v[68:71]
    buffer_load_dwordx4 v19, s[24:27], s11 offen offset:1024 lds
    v_mfma_f32_16x16x32_bf16 v[72:75], v[104:107], v[132:135], v[72:75]
    v_mfma_f32_16x16x32_bf16 v[76:79], v[100:103], v[136:139], v[76:79]
    s_add_u32 m0, s9, 75776
    v_mfma_f32_16x16x32_bf16 v[80:83], v[104:107], v[136:139], v[80:83]
    v_mfma_f32_16x16x32_bf16 v[84:87], v[100:103], v[140:143], v[84:87]
    s_add_u32 s11, s60, 20480
    v_mfma_f32_16x16x32_bf16 v[88:91], v[104:107], v[140:143], v[88:91]
    v_mfma_f32_16x16x32_bf16 v[92:95], v[100:103], v[144:147], v[92:95]
    buffer_load_dwordx4 v18, s[24:27], s11 offen lds
    v_mfma_f32_16x16x32_bf16 v[96:99], v[104:107], v[144:147], v[96:99]
    s_waitcnt vmcnt(12) lgkmcnt(0)
    s_barrier
    v_mfma_f32_16x16x32_bf16 v[20:23], v[148:151], v[156:159], v[20:23]
    ds_read_b128 v[100:103], v10 offset:0
    v_mfma_f32_16x16x32_bf16 v[24:27], v[152:155], v[156:159], v[24:27]
    ds_read_b128 v[108:111], v14 offset:0
    buffer_load_dwordx4 v19, s[24:27], s11 offen offset:1024 lds
    v_mfma_f32_16x16x32_bf16 v[28:31], v[148:151], v[160:163], v[28:31]
    ds_read_b128 v[104:107], v10 offset:2048
    v_mfma_f32_16x16x32_bf16 v[32:35], v[152:155], v[160:163], v[32:35]
    ds_read_b128 v[112:115], v14 offset:9216
    s_add_u32 m0, s9, 77824
    v_mfma_f32_16x16x32_bf16 v[36:39], v[148:151], v[164:167], v[36:39]
    ds_read_b128 v[116:119], v14 offset:1024
    v_mfma_f32_16x16x32_bf16 v[40:43], v[152:155], v[164:167], v[40:43]
    ds_read_b128 v[120:123], v14 offset:10240
    s_add_u32 s11, s60, 40960
    v_mfma_f32_16x16x32_bf16 v[44:47], v[148:151], v[168:171], v[44:47]
    ds_read_b128 v[124:127], v14 offset:2048
    v_mfma_f32_16x16x32_bf16 v[48:51], v[152:155], v[168:171], v[48:51]
    ds_read_b128 v[128:131], v14 offset:11264
    buffer_load_dwordx4 v18, s[24:27], s11 offen lds
    v_mfma_f32_16x16x32_bf16 v[52:55], v[148:151], v[172:175], v[52:55]
    ds_read_b128 v[132:135], v14 offset:3072
    v_mfma_f32_16x16x32_bf16 v[56:59], v[152:155], v[172:175], v[56:59]
    ds_read_b128 v[136:139], v14 offset:12288
    buffer_load_dwordx4 v19, s[24:27], s11 offen offset:1024 lds
    v_mfma_f32_16x16x32_bf16 v[60:63], v[148:151], v[176:179], v[60:63]
    ds_read_b128 v[140:143], v14 offset:4096
    v_mfma_f32_16x16x32_bf16 v[64:67], v[152:155], v[176:179], v[64:67]
    ds_read_b128 v[144:147], v14 offset:13312
    s_add_u32 m0, s9, 79872
    v_mfma_f32_16x16x32_bf16 v[68:71], v[148:151], v[180:183], v[68:71]
    v_mfma_f32_16x16x32_bf16 v[72:75], v[152:155], v[180:183], v[72:75]
    s_add_u32 s11, s60, 61440
    v_mfma_f32_16x16x32_bf16 v[76:79], v[148:151], v[184:187], v[76:79]
    v_mfma_f32_16x16x32_bf16 v[80:83], v[152:155], v[184:187], v[80:83]
    buffer_load_dwordx4 v18, s[24:27], s11 offen lds
    v_mfma_f32_16x16x32_bf16 v[84:87], v[148:151], v[188:191], v[84:87]
    v_mfma_f32_16x16x32_bf16 v[88:91], v[152:155], v[188:191], v[88:91]
    buffer_load_dwordx4 v19, s[24:27], s11 offen offset:1024 lds
    v_mfma_f32_16x16x32_bf16 v[92:95], v[148:151], v[192:195], v[92:95]
    v_mfma_f32_16x16x32_bf16 v[96:99], v[152:155], v[192:195], v[96:99]
    s_waitcnt lgkmcnt(0)
    v_mfma_f32_16x16x32_bf16 v[20:23], v[100:103], v[108:111], v[20:23]
    ds_read_b128 v[148:151], v11 offset:0
    v_mfma_f32_16x16x32_bf16 v[24:27], v[104:107], v[108:111], v[24:27]
    ds_read_b128 v[156:159], v15 offset:0
    v_mfma_f32_16x16x32_bf16 v[28:31], v[100:103], v[112:115], v[28:31]
    ds_read_b128 v[152:155], v11 offset:2048
    v_mfma_f32_16x16x32_bf16 v[32:35], v[104:107], v[112:115], v[32:35]
    ds_read_b128 v[160:163], v15 offset:9216
    v_mfma_f32_16x16x32_bf16 v[36:39], v[100:103], v[116:119], v[36:39]
    ds_read_b128 v[164:167], v15 offset:1024
    v_mfma_f32_16x16x32_bf16 v[40:43], v[104:107], v[116:119], v[40:43]
    ds_read_b128 v[168:171], v15 offset:10240
    v_mfma_f32_16x16x32_bf16 v[44:47], v[100:103], v[120:123], v[44:47]
    ds_read_b128 v[172:175], v15 offset:2048
    v_mfma_f32_16x16x32_bf16 v[48:51], v[104:107], v[120:123], v[48:51]
    ds_read_b128 v[176:179], v15 offset:11264
    v_mfma_f32_16x16x32_bf16 v[52:55], v[100:103], v[124:127], v[52:55]
    ds_read_b128 v[180:183], v15 offset:3072
    v_mfma_f32_16x16x32_bf16 v[56:59], v[104:107], v[124:127], v[56:59]
    ds_read_b128 v[184:187], v15 offset:12288
    v_mfma_f32_16x16x32_bf16 v[60:63], v[100:103], v[128:131], v[60:63]
    ds_read_b128 v[188:191], v15 offset:4096
    v_mfma_f32_16x16x32_bf16 v[64:67], v[104:107], v[128:131], v[64:67]
    ds_read_b128 v[192:195], v15 offset:13312
    v_mfma_f32_16x16x32_bf16 v[68:71], v[100:103], v[132:135], v[68:71]
    v_mfma_f32_16x16x32_bf16 v[72:75], v[104:107], v[132:135], v[72:75]
    v_mfma_f32_16x16x32_bf16 v[76:79], v[100:103], v[136:139], v[76:79]
    v_mfma_f32_16x16x32_bf16 v[80:83], v[104:107], v[136:139], v[80:83]
    v_mfma_f32_16x16x32_bf16 v[84:87], v[100:103], v[140:143], v[84:87]
    v_mfma_f32_16x16x32_bf16 v[88:91], v[104:107], v[140:143], v[88:91]
    v_mfma_f32_16x16x32_bf16 v[92:95], v[100:103], v[144:147], v[92:95]
    v_mfma_f32_16x16x32_bf16 v[96:99], v[104:107], v[144:147], v[96:99]
    s_waitcnt vmcnt(8) lgkmcnt(0)
    s_barrier
    v_mfma_f32_16x16x32_bf16 v[20:23], v[148:151], v[156:159], v[20:23]
    ds_read_b128 v[100:103], v10 offset:36864
    v_mfma_f32_16x16x32_bf16 v[24:27], v[152:155], v[156:159], v[24:27]
    ds_read_b128 v[108:111], v14 offset:36864
    v_mfma_f32_16x16x32_bf16 v[28:31], v[148:151], v[160:163], v[28:31]
    ds_read_b128 v[104:107], v10 offset:38912
    v_mfma_f32_16x16x32_bf16 v[32:35], v[152:155], v[160:163], v[32:35]
    ds_read_b128 v[112:115], v14 offset:46080
    v_mfma_f32_16x16x32_bf16 v[36:39], v[148:151], v[164:167], v[36:39]
    ds_read_b128 v[116:119], v14 offset:37888
    v_mfma_f32_16x16x32_bf16 v[40:43], v[152:155], v[164:167], v[40:43]
    ds_read_b128 v[120:123], v14 offset:47104
    v_mfma_f32_16x16x32_bf16 v[44:47], v[148:151], v[168:171], v[44:47]
    ds_read_b128 v[124:127], v14 offset:38912
    v_mfma_f32_16x16x32_bf16 v[48:51], v[152:155], v[168:171], v[48:51]
    ds_read_b128 v[128:131], v14 offset:48128
    v_mfma_f32_16x16x32_bf16 v[52:55], v[148:151], v[172:175], v[52:55]
    ds_read_b128 v[132:135], v14 offset:39936
    v_mfma_f32_16x16x32_bf16 v[56:59], v[152:155], v[172:175], v[56:59]
    ds_read_b128 v[136:139], v14 offset:49152
    v_mfma_f32_16x16x32_bf16 v[60:63], v[148:151], v[176:179], v[60:63]
    ds_read_b128 v[140:143], v14 offset:40960
    v_mfma_f32_16x16x32_bf16 v[64:67], v[152:155], v[176:179], v[64:67]
    ds_read_b128 v[144:147], v14 offset:50176
    v_mfma_f32_16x16x32_bf16 v[68:71], v[148:151], v[180:183], v[68:71]
    v_mfma_f32_16x16x32_bf16 v[72:75], v[152:155], v[180:183], v[72:75]
    v_mfma_f32_16x16x32_bf16 v[76:79], v[148:151], v[184:187], v[76:79]
    v_mfma_f32_16x16x32_bf16 v[80:83], v[152:155], v[184:187], v[80:83]
    v_mfma_f32_16x16x32_bf16 v[84:87], v[148:151], v[188:191], v[84:87]
    v_mfma_f32_16x16x32_bf16 v[88:91], v[152:155], v[188:191], v[88:91]
    v_mfma_f32_16x16x32_bf16 v[92:95], v[148:151], v[192:195], v[92:95]
    v_mfma_f32_16x16x32_bf16 v[96:99], v[152:155], v[192:195], v[96:99]
    s_waitcnt lgkmcnt(0)
    v_mfma_f32_16x16x32_bf16 v[20:23], v[100:103], v[108:111], v[20:23]
    ds_read_b128 v[148:151], v11 offset:36864
    v_and_b32 v2, 15, v0
    v_mfma_f32_16x16x32_bf16 v[24:27], v[104:107], v[108:111], v[24:27]
    ds_read_b128 v[156:159], v15 offset:36864
    v_lshlrev_b32_e64 v1, 3, v2
    v_mfma_f32_16x16x32_bf16 v[28:31], v[100:103], v[112:115], v[28:31]
    ds_read_b128 v[152:155], v11 offset:38912
    v_mfma_f32_16x16x32_bf16 v[32:35], v[104:107], v[112:115], v[32:35]
    ds_read_b128 v[160:163], v15 offset:46080
    v_lshlrev_b32_e64 v2, 4, v2
    v_mfma_f32_16x16x32_bf16 v[36:39], v[100:103], v[116:119], v[36:39]
    ds_read_b128 v[164:167], v15 offset:37888
    s_lshl_b32 s13, s8, 7
    v_mfma_f32_16x16x32_bf16 v[40:43], v[104:107], v[116:119], v[40:43]
    ds_read_b128 v[168:171], v15 offset:47104
    v_mfma_f32_16x16x32_bf16 v[44:47], v[100:103], v[120:123], v[44:47]
    ds_read_b128 v[172:175], v15 offset:38912
    s_add_u32 s13, s13, 157696
    v_mfma_f32_16x16x32_bf16 v[48:51], v[104:107], v[120:123], v[48:51]
    ds_read_b128 v[176:179], v15 offset:48128
    v_add_u32 v1, s13, v1
    v_mfma_f32_16x16x32_bf16 v[52:55], v[100:103], v[124:127], v[52:55]
    ds_read_b128 v[180:183], v15 offset:39936
    v_mfma_f32_16x16x32_bf16 v[56:59], v[104:107], v[124:127], v[56:59]
    ds_read_b128 v[184:187], v15 offset:49152
    v_lshrrev_b32_e64 v7, 1, v251
    v_mfma_f32_16x16x32_bf16 v[60:63], v[100:103], v[128:131], v[60:63]
    ds_read_b128 v[188:191], v15 offset:40960
    v_mfma_f32_16x16x32_bf16 v[64:67], v[104:107], v[128:131], v[64:67]
    ds_read_b128 v[192:195], v15 offset:50176
    v_lshl_add_u32 v4, v7, 2, v1
    v_mfma_f32_16x16x32_bf16 v[68:71], v[100:103], v[132:135], v[68:71]
    v_add_u32 v4, 384, v4
    v_mfma_f32_16x16x32_bf16 v[72:75], v[104:107], v[132:135], v[72:75]
    v_mfma_f32_16x16x32_bf16 v[76:79], v[100:103], v[136:139], v[76:79]
    v_and_b32_e64 v6, 1, v251
    v_mfma_f32_16x16x32_bf16 v[80:83], v[104:107], v[136:139], v[80:83]
    v_mul_u32_u24 v3, 896, v6
    v_mfma_f32_16x16x32_bf16 v[84:87], v[100:103], v[140:143], v[84:87]
    v_mfma_f32_16x16x32_bf16 v[88:91], v[104:107], v[140:143], v[88:91]
    v_add_u32_e64 v3, v3, v4
    v_mfma_f32_16x16x32_bf16 v[92:95], v[100:103], v[144:147], v[92:95]
    v_mfma_f32_16x16x32_bf16 v[96:99], v[104:107], v[144:147], v[96:99]
    s_waitcnt lgkmcnt(0)
    s_barrier
    v_mfma_f32_16x16x32_bf16 v[20:23], v[148:151], v[156:159], v[20:23]
    s_lshr_b32 s12, s8, 1
    s_lshl_b32 s12, s12, 8
    v_mfma_f32_16x16x32_bf16 v[24:27], v[152:155], v[156:159], v[24:27]
    s_and_b32 s13, s8, 1
    v_mfma_f32_16x16x32_bf16 v[28:31], v[148:151], v[160:163], v[28:31]
    s_lshl_b32 s13, s13, 3
    v_mfma_f32_16x16x32_bf16 v[32:35], v[152:155], v[160:163], v[32:35]
    s_add_u32 s12, s12, s13
    s_add_u32 s12, s12, 153856
    v_mfma_f32_16x16x32_bf16 v[36:39], v[148:151], v[164:167], v[36:39]
    v_lshl_add_u32 v15, v7, 2, v2
    v_mfma_f32_16x16x32_bf16 v[40:43], v[152:155], v[164:167], v[40:43]
    v_add_u32 v15, s12, v15
    v_mfma_f32_16x16x32_bf16 v[44:47], v[148:151], v[168:171], v[44:47]
    v_lshl_add_u32 v14, v6, 9, v15
    v_mfma_f32_16x16x32_bf16 v[48:51], v[152:155], v[168:171], v[48:51]
    v_add_u32 v16, 153856, v2
    v_mul_u32_u24 v17, 1280, v251
    v_mfma_f32_16x16x32_bf16 v[52:55], v[148:151], v[172:175], v[52:55]
    v_add_u32_e64 v17, v17, v2
    v_mfma_f32_16x16x32_bf16 v[56:59], v[152:155], v[172:175], v[56:59]
    v_lshlrev_b32_e64 v6, 6, v6
    v_mfma_f32_16x16x32_bf16 v[60:63], v[148:151], v[176:179], v[60:63]
    v_xor_b32_e64 v6, v6, v2
    v_mfma_f32_16x16x32_bf16 v[64:67], v[152:155], v[176:179], v[64:67]
    v_lshl_add_u32 v5, v251, 8, v6
    v_add_u32_e64 v5, s9, v5
    v_mfma_f32_16x16x32_bf16 v[68:71], v[148:151], v[180:183], v[68:71]
    v_lshl_add_u32 v246, v251, 2, s8
    v_mfma_f32_16x16x32_bf16 v[72:75], v[152:155], v[180:183], v[72:75]
    v_min_u32_e64 v247, 4, v246
    v_mfma_f32_16x16x32_bf16 v[76:79], v[148:151], v[184:187], v[76:79]
    v_lshl_add_u32 v248, v247, 7, v250
    v_mfma_f32_16x16x32_bf16 v[80:83], v[152:155], v[184:187], v[80:83]
    ds_read_b64 v[248:249], v248 offset:4480
    v_lshl_add_u32 v6, v246, 8, v2
    v_mfma_f32_16x16x32_bf16 v[84:87], v[148:151], v[188:191], v[84:87]
    v_mul_u32_u24 v7, 896, v247
    v_mfma_f32_16x16x32_bf16 v[88:91], v[152:155], v[188:191], v[88:91]
    v_add_u32_e64 v7, v7, v250
    v_mfma_f32_16x16x32_bf16 v[92:95], v[148:151], v[192:195], v[92:95]
    v_add_u32 v7, 10624, v7
    v_mfma_f32_16x16x32_bf16 v[96:99], v[152:155], v[192:195], v[96:99]
    s_waitcnt lgkmcnt(0)
    v_pk_fma_f32 v[110:111], v[20:21], v[206:207], v[22:23] op_sel_hi:[1,0,1]
    v_pk_fma_f32 v[112:113], v[28:29], v[206:207], v[30:31] op_sel_hi:[1,0,1]
    v_pk_fma_f32 v[110:111], v[28:29], v[206:207], v[110:111] op_sel:[0,1,0] op_sel_hi:[1,1,1] neg_lo:[1,0,0] neg_hi:[1,0,0]
    v_pk_fma_f32 v[112:113], v[20:21], v[206:207], v[112:113] op_sel:[0,1,0] op_sel_hi:[1,1,1]
    v_pk_fma_f32 v[114:115], v[110:111], v[206:207], v[24:25] op_sel_hi:[1,0,1]
    v_pk_fma_f32 v[116:117], v[112:113], v[206:207], v[32:33] op_sel_hi:[1,0,1]
    v_pk_fma_f32 v[114:115], v[112:113], v[206:207], v[114:115] op_sel:[0,1,0] op_sel_hi:[1,1,1] neg_lo:[1,0,0] neg_hi:[1,0,0]
    v_pk_fma_f32 v[116:117], v[110:111], v[206:207], v[116:117] op_sel:[0,1,0] op_sel_hi:[1,1,1]
    v_pk_fma_f32 v[110:111], v[114:115], v[206:207], v[26:27] op_sel_hi:[1,0,1]
    v_pk_fma_f32 v[112:113], v[116:117], v[206:207], v[34:35] op_sel_hi:[1,0,1]
    v_pk_fma_f32 v[110:111], v[116:117], v[206:207], v[110:111] op_sel:[0,1,0] op_sel_hi:[1,1,1] neg_lo:[1,0,0] neg_hi:[1,0,0]
    v_pk_fma_f32 v[112:113], v[114:115], v[206:207], v[112:113] op_sel:[0,1,0] op_sel_hi:[1,1,1]
    v_fma_f32 v180, v196, v110, v111
    v_fma_f32 v181, v196, v112, v113
    s_add_u32 m0, s9, 110592
    s_add_u32 s11, s60, 81920
    buffer_load_dwordx4 v18, s[24:27], s11 offen lds
    v_fma_f32 v180, -v197, v112, v180
    v_fma_f32 v181, v197, v110, v181
    v_pk_mul_f32 v[100:101], v[180:181], v[216:217] op_sel_hi:[1,0]
    v_pk_fma_f32 v[100:101], v[180:181], v[216:217], v[100:101] op_sel:[1,1,0] op_sel_hi:[0,1,1] neg_lo:[1,0,0]
    v_pk_fma_f32 v[110:111], v[36:37], v[208:209], v[38:39] op_sel_hi:[1,0,1]
    v_pk_fma_f32 v[112:113], v[44:45], v[208:209], v[46:47] op_sel_hi:[1,0,1]
    v_pk_fma_f32 v[110:111], v[44:45], v[208:209], v[110:111] op_sel:[0,1,0] op_sel_hi:[1,1,1] neg_lo:[1,0,0] neg_hi:[1,0,0]
    v_pk_fma_f32 v[112:113], v[36:37], v[208:209], v[112:113] op_sel:[0,1,0] op_sel_hi:[1,1,1]
    v_pk_fma_f32 v[114:115], v[110:111], v[208:209], v[40:41] op_sel_hi:[1,0,1]
    v_pk_fma_f32 v[116:117], v[112:113], v[208:209], v[48:49] op_sel_hi:[1,0,1]
    v_pk_fma_f32 v[114:115], v[112:113], v[208:209], v[114:115] op_sel:[0,1,0] op_sel_hi:[1,1,1] neg_lo:[1,0,0] neg_hi:[1,0,0]
    v_pk_fma_f32 v[116:117], v[110:111], v[208:209], v[116:117] op_sel:[0,1,0] op_sel_hi:[1,1,1]
    v_pk_fma_f32 v[110:111], v[114:115], v[208:209], v[42:43] op_sel_hi:[1,0,1]
    v_pk_fma_f32 v[112:113], v[116:117], v[208:209], v[50:51] op_sel_hi:[1,0,1]
    buffer_load_dwordx4 v19, s[24:27], s11 offen offset:1024 lds
    v_pk_fma_f32 v[110:111], v[116:117], v[208:209], v[110:111] op_sel:[0,1,0] op_sel_hi:[1,1,1] neg_lo:[1,0,0] neg_hi:[1,0,0]
    v_pk_fma_f32 v[112:113], v[114:115], v[208:209], v[112:113] op_sel:[0,1,0] op_sel_hi:[1,1,1]
    v_fma_f32 v182, v198, v110, v111
    v_fma_f32 v183, v198, v112, v113
    v_fma_f32 v182, -v199, v112, v182
    v_fma_f32 v183, v199, v110, v183
    v_pk_mul_f32 v[102:103], v[182:183], v[218:219] op_sel_hi:[1,0]
    v_pk_fma_f32 v[102:103], v[182:183], v[218:219], v[102:103] op_sel:[1,1,0] op_sel_hi:[0,1,1] neg_lo:[1,0,0]
    v_pk_fma_f32 v[110:111], v[52:53], v[210:211], v[54:55] op_sel_hi:[1,0,1]
    v_pk_fma_f32 v[112:113], v[60:61], v[210:211], v[62:63] op_sel_hi:[1,0,1]
    v_pk_fma_f32 v[110:111], v[60:61], v[210:211], v[110:111] op_sel:[0,1,0] op_sel_hi:[1,1,1] neg_lo:[1,0,0] neg_hi:[1,0,0]
    v_pk_fma_f32 v[112:113], v[52:53], v[210:211], v[112:113] op_sel:[0,1,0] op_sel_hi:[1,1,1]
    v_pk_fma_f32 v[114:115], v[110:111], v[210:211], v[56:57] op_sel_hi:[1,0,1]
    v_pk_fma_f32 v[116:117], v[112:113], v[210:211], v[64:65] op_sel_hi:[1,0,1]
    s_add_u32 m0, s9, 112640
    s_add_u32 s11, s61, 0
    buffer_load_dwordx4 v18, s[24:27], s11 offen lds
    v_pk_fma_f32 v[114:115], v[112:113], v[210:211], v[114:115] op_sel:[0,1,0] op_sel_hi:[1,1,1] neg_lo:[1,0,0] neg_hi:[1,0,0]
    v_pk_fma_f32 v[116:117], v[110:111], v[210:211], v[116:117] op_sel:[0,1,0] op_sel_hi:[1,1,1]
    v_pk_fma_f32 v[110:111], v[114:115], v[210:211], v[58:59] op_sel_hi:[1,0,1]
    v_pk_fma_f32 v[112:113], v[116:117], v[210:211], v[66:67] op_sel_hi:[1,0,1]
    v_pk_fma_f32 v[110:111], v[116:117], v[210:211], v[110:111] op_sel:[0,1,0] op_sel_hi:[1,1,1] neg_lo:[1,0,0] neg_hi:[1,0,0]
    v_pk_fma_f32 v[112:113], v[114:115], v[210:211], v[112:113] op_sel:[0,1,0] op_sel_hi:[1,1,1]
    v_fma_f32 v184, v200, v110, v111
    v_fma_f32 v185, v200, v112, v113
    v_fma_f32 v184, -v201, v112, v184
    v_fma_f32 v185, v201, v110, v185
    v_pk_mul_f32 v[104:105], v[184:185], v[220:221] op_sel_hi:[1,0]
    v_pk_fma_f32 v[104:105], v[184:185], v[220:221], v[104:105] op_sel:[1,1,0] op_sel_hi:[0,1,1] neg_lo:[1,0,0]
    v_pk_fma_f32 v[110:111], v[68:69], v[212:213], v[70:71] op_sel_hi:[1,0,1]
    v_pk_fma_f32 v[112:113], v[76:77], v[212:213], v[78:79] op_sel_hi:[1,0,1]
    buffer_load_dwordx4 v19, s[24:27], s11 offen offset:1024 lds
    v_pk_fma_f32 v[110:111], v[76:77], v[212:213], v[110:111] op_sel:[0,1,0] op_sel_hi:[1,1,1] neg_lo:[1,0,0] neg_hi:[1,0,0]
    v_pk_fma_f32 v[112:113], v[68:69], v[212:213], v[112:113] op_sel:[0,1,0] op_sel_hi:[1,1,1]
    v_pk_fma_f32 v[114:115], v[110:111], v[212:213], v[72:73] op_sel_hi:[1,0,1]
    v_pk_fma_f32 v[116:117], v[112:113], v[212:213], v[80:81] op_sel_hi:[1,0,1]
    v_pk_fma_f32 v[114:115], v[112:113], v[212:213], v[114:115] op_sel:[0,1,0] op_sel_hi:[1,1,1] neg_lo:[1,0,0] neg_hi:[1,0,0]
    v_pk_fma_f32 v[116:117], v[110:111], v[212:213], v[116:117] op_sel:[0,1,0] op_sel_hi:[1,1,1]
    v_pk_fma_f32 v[110:111], v[114:115], v[212:213], v[74:75] op_sel_hi:[1,0,1]
    v_pk_fma_f32 v[112:113], v[116:117], v[212:213], v[82:83] op_sel_hi:[1,0,1]
    v_pk_fma_f32 v[110:111], v[116:117], v[212:213], v[110:111] op_sel:[0,1,0] op_sel_hi:[1,1,1] neg_lo:[1,0,0] neg_hi:[1,0,0]
    v_pk_fma_f32 v[112:113], v[114:115], v[212:213], v[112:113] op_sel:[0,1,0] op_sel_hi:[1,1,1]
    v_fma_f32 v186, v202, v110, v111
    v_fma_f32 v187, v202, v112, v113
    v_fma_f32 v186, -v203, v112, v186
    v_fma_f32 v187, v203, v110, v187
    s_add_u32 m0, s9, 114688
    s_add_u32 s11, s61, 20480
    buffer_load_dwordx4 v18, s[24:27], s11 offen lds
    v_pk_mul_f32 v[106:107], v[186:187], v[222:223] op_sel_hi:[1,0]
    v_pk_fma_f32 v[106:107], v[186:187], v[222:223], v[106:107] op_sel:[1,1,0] op_sel_hi:[0,1,1] neg_lo:[1,0,0]
    v_pk_fma_f32 v[110:111], v[84:85], v[214:215], v[86:87] op_sel_hi:[1,0,1]
    v_pk_fma_f32 v[112:113], v[92:93], v[214:215], v[94:95] op_sel_hi:[1,0,1]
    v_pk_fma_f32 v[110:111], v[92:93], v[214:215], v[110:111] op_sel:[0,1,0] op_sel_hi:[1,1,1] neg_lo:[1,0,0] neg_hi:[1,0,0]
    v_pk_fma_f32 v[112:113], v[84:85], v[214:215], v[112:113] op_sel:[0,1,0] op_sel_hi:[1,1,1]
    v_pk_fma_f32 v[114:115], v[110:111], v[214:215], v[88:89] op_sel_hi:[1,0,1]
    v_pk_fma_f32 v[116:117], v[112:113], v[214:215], v[96:97] op_sel_hi:[1,0,1]
    v_pk_fma_f32 v[114:115], v[112:113], v[214:215], v[114:115] op_sel:[0,1,0] op_sel_hi:[1,1,1] neg_lo:[1,0,0] neg_hi:[1,0,0]
    v_pk_fma_f32 v[116:117], v[110:111], v[214:215], v[116:117] op_sel:[0,1,0] op_sel_hi:[1,1,1]
    v_pk_fma_f32 v[110:111], v[114:115], v[214:215], v[90:91] op_sel_hi:[1,0,1]
    v_pk_fma_f32 v[112:113], v[116:117], v[214:215], v[98:99] op_sel_hi:[1,0,1]
    v_pk_fma_f32 v[110:111], v[116:117], v[214:215], v[110:111] op_sel:[0,1,0] op_sel_hi:[1,1,1] neg_lo:[1,0,0] neg_hi:[1,0,0]
    v_pk_fma_f32 v[112:113], v[114:115], v[214:215], v[112:113] op_sel:[0,1,0] op_sel_hi:[1,1,1]
    buffer_load_dwordx4 v19, s[24:27], s11 offen offset:1024 lds
    v_fma_f32 v188, v204, v110, v111
    v_fma_f32 v189, v204, v112, v113
    v_fma_f32 v188, -v205, v112, v188
    v_fma_f32 v189, v205, v110, v189
    v_pk_mul_f32 v[108:109], v[188:189], v[224:225] op_sel_hi:[1,0]
    v_pk_fma_f32 v[108:109], v[188:189], v[224:225], v[108:109] op_sel:[1,1,0] op_sel_hi:[0,1,1] neg_lo:[1,0,0]
    v_permlane32_swap_b32 v100, v101
    v_permlane32_swap_b32 v102, v103
    v_permlane32_swap_b32 v104, v105
    v_permlane32_swap_b32 v106, v107
    v_permlane32_swap_b32 v108, v109
    v_add_f32 v108, v108, v109
    v_add_f32 v100, v100, v101
    v_mov_b32 v109, v108
    v_add_f32 v102, v102, v103
    v_add_f32 v104, v104, v105
    v_add_f32 v106, v106, v107
    v_permlane16_swap_b32 v108, v109
    v_permlane16_swap_b32 v100, v102
    v_permlane16_swap_b32 v104, v106
    v_add_f32 v108, v108, v109
    v_add_f32 v100, v100, v102
    v_add_f32_e64 v104, v104, v106
    ds_write_b32 v4, v108 offset:3584
    ds_write_b32 v3, v100
    ds_write_b32 v3, v104 offset:1792
    v_cmp_gt_u32 vcc, 5, v246
    v_mov_b32 v115, s10
    v_mov_b32 v117, s10
    s_mov_b64 s[58:59], s[14:15]
    s_waitcnt lgkmcnt(0)
    s_barrier
    ds_read_b64 v[120:121], v7 offset:0
    ds_read_b64 v[122:123], v7 offset:128
    ds_read_b64 v[124:125], v7 offset:256
    ds_read_b64 v[126:127], v7 offset:384
    ds_read_b64 v[206:207], v250 offset:1920
    ds_read_b64 v[208:209], v250 offset:2048
    ds_read_b64 v[210:211], v250 offset:2176
    ds_read_b64 v[212:213], v250 offset:2304
    ds_read_b64 v[214:215], v250 offset:2432
    ds_read_b64 v[216:217], v250 offset:2560
    ds_read_b64 v[218:219], v250 offset:2688
    ds_read_b64 v[220:221], v250 offset:2816
    ds_read_b64 v[222:223], v250 offset:2944
    ds_read_b64 v[224:225], v250 offset:3072
    s_and_saveexec_b64 s[14:15], vcc
    s_waitcnt lgkmcnt(10)
    v_pk_fma_f32 v[128:129], v[120:121], v[248:249], v[122:123] op_sel_hi:[1,0,1]
    v_pk_fma_f32 v[128:129], v[120:121], v[248:249], v[128:129] op_sel:[1,1,0] op_sel_hi:[0,1,1] neg_lo:[1,0,0]
    v_pk_fma_f32 v[130:131], v[128:129], v[248:249], v[124:125] op_sel_hi:[1,0,1]
    v_pk_fma_f32 v[130:131], v[128:129], v[248:249], v[130:131] op_sel:[1,1,0] op_sel_hi:[0,1,1] neg_lo:[1,0,0]
    v_pk_fma_f32 v[128:129], v[130:131], v[248:249], v[126:127] op_sel_hi:[1,0,1]
    v_pk_fma_f32 v[128:129], v[130:131], v[248:249], v[128:129] op_sel:[1,1,0] op_sel_hi:[0,1,1] neg_lo:[1,0,0]
    v_mov_b32 v114, v128
    v_mov_b32 v116, v129
    buffer_store_dwordx4 v[114:117], v6, s[32:35], s28 offen sc1
    s_mov_b64 exec, -1
    s_add_u32 m0, s9, 116736
    s_add_u32 s11, s61, 40960
    buffer_load_dwordx4 v18, s[24:27], s11 offen lds
    s_waitcnt lgkmcnt(0)
    v_pk_mul_f32 v[100:101], v[206:207], v[20:21] op_sel:[0,0] op_sel_hi:[1,0]
    v_pk_fma_f32 v[100:101], v[206:207], v[28:29], v[100:101] op_sel:[1,0,0] op_sel_hi:[0,0,1] neg_lo:[1,0,0]
    v_pk_mul_f32 v[102:103], v[206:207], v[20:21] op_sel:[0,1] op_sel_hi:[1,1]
    v_pk_fma_f32 v[102:103], v[206:207], v[28:29], v[102:103] op_sel:[1,1,0] op_sel_hi:[0,1,1] neg_lo:[1,0,0]
    v_pk_mul_f32 v[104:105], v[206:207], v[22:23] op_sel:[0,0] op_sel_hi:[1,0]
    v_pk_fma_f32 v[104:105], v[206:207], v[30:31], v[104:105] op_sel:[1,0,0] op_sel_hi:[0,0,1] neg_lo:[1,0,0]
    v_pk_mul_f32 v[106:107], v[206:207], v[22:23] op_sel:[0,1] op_sel_hi:[1,1]
    v_pk_fma_f32 v[106:107], v[206:207], v[30:31], v[106:107] op_sel:[1,1,0] op_sel_hi:[0,1,1] neg_lo:[1,0,0]
    buffer_load_dwordx4 v19, s[24:27], s11 offen offset:1024 lds
    v_pk_mul_f32 v[108:109], v[206:207], v[24:25] op_sel:[0,0] op_sel_hi:[1,0]
    v_pk_fma_f32 v[108:109], v[206:207], v[32:33], v[108:109] op_sel:[1,0,0] op_sel_hi:[0,0,1] neg_lo:[1,0,0]
    v_pk_mul_f32 v[110:111], v[206:207], v[24:25] op_sel:[0,1] op_sel_hi:[1,1]
    v_pk_fma_f32 v[110:111], v[206:207], v[32:33], v[110:111] op_sel:[1,1,0] op_sel_hi:[0,1,1] neg_lo:[1,0,0]
    v_pk_mul_f32 v[112:113], v[206:207], v[26:27] op_sel:[0,0] op_sel_hi:[1,0]
    v_pk_fma_f32 v[112:113], v[206:207], v[34:35], v[112:113] op_sel:[1,0,0] op_sel_hi:[0,0,1] neg_lo:[1,0,0]
    v_pk_mul_f32 v[114:115], v[206:207], v[26:27] op_sel:[0,1] op_sel_hi:[1,1]
    v_pk_fma_f32 v[114:115], v[206:207], v[34:35], v[114:115] op_sel:[1,1,0] op_sel_hi:[0,1,1] neg_lo:[1,0,0]
    v_pk_mul_f32 v[116:117], v[208:209], v[36:37] op_sel:[0,0] op_sel_hi:[1,0]
    v_pk_fma_f32 v[116:117], v[208:209], v[44:45], v[116:117] op_sel:[1,0,0] op_sel_hi:[0,0,1] neg_lo:[1,0,0]
    v_pk_mul_f32 v[118:119], v[208:209], v[36:37] op_sel:[0,1] op_sel_hi:[1,1]
    v_pk_fma_f32 v[118:119], v[208:209], v[44:45], v[118:119] op_sel:[1,1,0] op_sel_hi:[0,1,1] neg_lo:[1,0,0]
    v_pk_mul_f32 v[120:121], v[208:209], v[38:39] op_sel:[0,0] op_sel_hi:[1,0]
    v_pk_fma_f32 v[120:121], v[208:209], v[46:47], v[120:121] op_sel:[1,0,0] op_sel_hi:[0,0,1] neg_lo:[1,0,0]
    s_add_u32 m0, s9, 0
    s_add_u32 s11, s61, 61440
    buffer_load_dwordx4 v18, s[24:27], s11 offen lds
    v_pk_mul_f32 v[122:123], v[208:209], v[38:39] op_sel:[0,1] op_sel_hi:[1,1]
    v_pk_fma_f32 v[122:123], v[208:209], v[46:47], v[122:123] op_sel:[1,1,0] op_sel_hi:[0,1,1] neg_lo:[1,0,0]
    v_pk_mul_f32 v[124:125], v[208:209], v[40:41] op_sel:[0,0] op_sel_hi:[1,0]
    v_pk_fma_f32 v[124:125], v[208:209], v[48:49], v[124:125] op_sel:[1,0,0] op_sel_hi:[0,0,1] neg_lo:[1,0,0]
    v_pk_mul_f32 v[126:127], v[208:209], v[40:41] op_sel:[0,1] op_sel_hi:[1,1]
    v_pk_fma_f32 v[126:127], v[208:209], v[48:49], v[126:127] op_sel:[1,1,0] op_sel_hi:[0,1,1] neg_lo:[1,0,0]
    v_pk_mul_f32 v[128:129], v[208:209], v[42:43] op_sel:[0,0] op_sel_hi:[1,0]
    v_pk_fma_f32 v[128:129], v[208:209], v[50:51], v[128:129] op_sel:[1,0,0] op_sel_hi:[0,0,1] neg_lo:[1,0,0]
    v_pk_mul_f32 v[130:131], v[208:209], v[42:43] op_sel:[0,1] op_sel_hi:[1,1]
    v_pk_fma_f32 v[130:131], v[208:209], v[50:51], v[130:131] op_sel:[1,1,0] op_sel_hi:[0,1,1] neg_lo:[1,0,0]
    v_pk_mul_f32 v[132:133], v[210:211], v[52:53] op_sel:[0,0] op_sel_hi:[1,0]
    v_pk_fma_f32 v[132:133], v[210:211], v[60:61], v[132:133] op_sel:[1,0,0] op_sel_hi:[0,0,1] neg_lo:[1,0,0]
    v_pk_mul_f32 v[134:135], v[210:211], v[52:53] op_sel:[0,1] op_sel_hi:[1,1]
    v_pk_fma_f32 v[134:135], v[210:211], v[60:61], v[134:135] op_sel:[1,1,0] op_sel_hi:[0,1,1] neg_lo:[1,0,0]
    buffer_load_dwordx4 v19, s[24:27], s11 offen offset:1024 lds
    v_pk_mul_f32 v[136:137], v[210:211], v[54:55] op_sel:[0,0] op_sel_hi:[1,0]
    v_pk_fma_f32 v[136:137], v[210:211], v[62:63], v[136:137] op_sel:[1,0,0] op_sel_hi:[0,0,1] neg_lo:[1,0,0]
    v_pk_mul_f32 v[138:139], v[210:211], v[54:55] op_sel:[0,1] op_sel_hi:[1,1]
    v_pk_fma_f32 v[138:139], v[210:211], v[62:63], v[138:139] op_sel:[1,1,0] op_sel_hi:[0,1,1] neg_lo:[1,0,0]
    v_pk_mul_f32 v[140:141], v[210:211], v[56:57] op_sel:[0,0] op_sel_hi:[1,0]
    v_pk_fma_f32 v[140:141], v[210:211], v[64:65], v[140:141] op_sel:[1,0,0] op_sel_hi:[0,0,1] neg_lo:[1,0,0]
    v_pk_mul_f32 v[142:143], v[210:211], v[56:57] op_sel:[0,1] op_sel_hi:[1,1]
    v_pk_fma_f32 v[142:143], v[210:211], v[64:65], v[142:143] op_sel:[1,1,0] op_sel_hi:[0,1,1] neg_lo:[1,0,0]
    v_pk_mul_f32 v[144:145], v[210:211], v[58:59] op_sel:[0,0] op_sel_hi:[1,0]
    v_pk_fma_f32 v[144:145], v[210:211], v[66:67], v[144:145] op_sel:[1,0,0] op_sel_hi:[0,0,1] neg_lo:[1,0,0]
    v_pk_mul_f32 v[146:147], v[210:211], v[58:59] op_sel:[0,1] op_sel_hi:[1,1]
    v_pk_fma_f32 v[146:147], v[210:211], v[66:67], v[146:147] op_sel:[1,1,0] op_sel_hi:[0,1,1] neg_lo:[1,0,0]
    v_pk_mul_f32 v[148:149], v[212:213], v[68:69] op_sel:[0,0] op_sel_hi:[1,0]
    v_pk_fma_f32 v[148:149], v[212:213], v[76:77], v[148:149] op_sel:[1,0,0] op_sel_hi:[0,0,1] neg_lo:[1,0,0]
    s_add_u32 m0, s9, 2048
    s_add_u32 s11, s61, 81920
    buffer_load_dwordx4 v18, s[24:27], s11 offen lds
    v_pk_mul_f32 v[150:151], v[212:213], v[68:69] op_sel:[0,1] op_sel_hi:[1,1]
    v_pk_fma_f32 v[150:151], v[212:213], v[76:77], v[150:151] op_sel:[1,1,0] op_sel_hi:[0,1,1] neg_lo:[1,0,0]
    v_pk_mul_f32 v[152:153], v[212:213], v[70:71] op_sel:[0,0] op_sel_hi:[1,0]
    v_pk_fma_f32 v[152:153], v[212:213], v[78:79], v[152:153] op_sel:[1,0,0] op_sel_hi:[0,0,1] neg_lo:[1,0,0]
    v_pk_mul_f32 v[154:155], v[212:213], v[70:71] op_sel:[0,1] op_sel_hi:[1,1]
    v_pk_fma_f32 v[154:155], v[212:213], v[78:79], v[154:155] op_sel:[1,1,0] op_sel_hi:[0,1,1] neg_lo:[1,0,0]
    v_pk_mul_f32 v[156:157], v[212:213], v[72:73] op_sel:[0,0] op_sel_hi:[1,0]
    v_pk_fma_f32 v[156:157], v[212:213], v[80:81], v[156:157] op_sel:[1,0,0] op_sel_hi:[0,0,1] neg_lo:[1,0,0]
    v_pk_mul_f32 v[158:159], v[212:213], v[72:73] op_sel:[0,1] op_sel_hi:[1,1]
    v_pk_fma_f32 v[158:159], v[212:213], v[80:81], v[158:159] op_sel:[1,1,0] op_sel_hi:[0,1,1] neg_lo:[1,0,0]
    v_pk_mul_f32 v[160:161], v[212:213], v[74:75] op_sel:[0,0] op_sel_hi:[1,0]
    v_pk_fma_f32 v[160:161], v[212:213], v[82:83], v[160:161] op_sel:[1,0,0] op_sel_hi:[0,0,1] neg_lo:[1,0,0]
    v_pk_mul_f32 v[162:163], v[212:213], v[74:75] op_sel:[0,1] op_sel_hi:[1,1]
    v_pk_fma_f32 v[162:163], v[212:213], v[82:83], v[162:163] op_sel:[1,1,0] op_sel_hi:[0,1,1] neg_lo:[1,0,0]
    buffer_load_dwordx4 v19, s[24:27], s11 offen offset:1024 lds
    v_pk_mul_f32 v[164:165], v[214:215], v[84:85] op_sel:[0,0] op_sel_hi:[1,0]
    v_pk_fma_f32 v[164:165], v[214:215], v[92:93], v[164:165] op_sel:[1,0,0] op_sel_hi:[0,0,1] neg_lo:[1,0,0]
    v_pk_mul_f32 v[166:167], v[214:215], v[84:85] op_sel:[0,1] op_sel_hi:[1,1]
    v_pk_fma_f32 v[166:167], v[214:215], v[92:93], v[166:167] op_sel:[1,1,0] op_sel_hi:[0,1,1] neg_lo:[1,0,0]
    v_pk_mul_f32 v[168:169], v[214:215], v[86:87] op_sel:[0,0] op_sel_hi:[1,0]
    v_pk_fma_f32 v[168:169], v[214:215], v[94:95], v[168:169] op_sel:[1,0,0] op_sel_hi:[0,0,1] neg_lo:[1,0,0]
    v_pk_mul_f32 v[170:171], v[214:215], v[86:87] op_sel:[0,1] op_sel_hi:[1,1]
    v_pk_fma_f32 v[170:171], v[214:215], v[94:95], v[170:171] op_sel:[1,1,0] op_sel_hi:[0,1,1] neg_lo:[1,0,0]
    v_pk_mul_f32 v[172:173], v[214:215], v[88:89] op_sel:[0,0] op_sel_hi:[1,0]
    v_pk_fma_f32 v[172:173], v[214:215], v[96:97], v[172:173] op_sel:[1,0,0] op_sel_hi:[0,0,1] neg_lo:[1,0,0]
    v_pk_mul_f32 v[174:175], v[214:215], v[88:89] op_sel:[0,1] op_sel_hi:[1,1]
    v_pk_fma_f32 v[174:175], v[214:215], v[96:97], v[174:175] op_sel:[1,1,0] op_sel_hi:[0,1,1] neg_lo:[1,0,0]
    v_pk_mul_f32 v[176:177], v[214:215], v[90:91] op_sel:[0,0] op_sel_hi:[1,0]
    v_pk_fma_f32 v[176:177], v[214:215], v[98:99], v[176:177] op_sel:[1,0,0] op_sel_hi:[0,0,1] neg_lo:[1,0,0]
    s_add_u32 m0, s9, 4096
    s_add_u32 s11, s62, 0
    buffer_load_dwordx4 v18, s[24:27], s11 offen lds
    v_pk_mul_f32 v[178:179], v[214:215], v[90:91] op_sel:[0,1] op_sel_hi:[1,1]
    v_pk_fma_f32 v[178:179], v[214:215], v[98:99], v[178:179] op_sel:[1,1,0] op_sel_hi:[0,1,1] neg_lo:[1,0,0]
    ds_read_b64 v[50:51], v230 offset:0
    ds_read_b64 v[52:53], v230 offset:128
    ds_read_b64 v[54:55], v230 offset:256
    ds_read_b64 v[56:57], v230 offset:384
    ds_read_b64 v[58:59], v230 offset:512
    ds_read_b64 v[70:71], v250 offset:4480
    ds_read_b64 v[72:73], v250 offset:4608
    ds_read_b64 v[74:75], v250 offset:4736
    ds_read_b64 v[76:77], v250 offset:4864
    ds_read_b64 v[78:79], v250 offset:4992
    ds_read_b64 v[80:81], v1 offset:0
    ds_read_b64 v[82:83], v1 offset:896
    buffer_load_dwordx4 v19, s[24:27], s11 offen offset:1024 lds
    ds_read_b64 v[84:85], v1 offset:1792
    ds_read_b64 v[86:87], v1 offset:2688
    ds_read_b64 v[88:89], v1 offset:3584
    ds_read_b64 v[90:91], v1 offset:128
    ds_read_b64 v[92:93], v1 offset:1024
    ds_read_b64 v[94:95], v1 offset:1920
    ds_read_b64 v[96:97], v1 offset:2816
    ds_read_b64 v[98:99], v1 offset:3712
    ds_read_b64 v[60:61], v228 offset:0
    ds_read_b64 v[62:63], v228 offset:128
    ds_read_b64 v[64:65], v228 offset:256
    ds_read_b64 v[66:67], v228 offset:384
    ds_read_b64 v[68:69], v228 offset:512
    v_mov_b64_e64 v[20:21], v[180:181]
    s_add_u32 m0, s9, 6144
    s_add_u32 s11, s62, 20480
    buffer_load_dwordx4 v18, s[24:27], s11 offen lds
    v_mov_b64 v[22:23], v[182:183]
    v_mov_b64 v[24:25], v[184:185]
    v_mov_b64 v[26:27], v[186:187]
    v_mov_b64 v[28:29], v[188:189]
    v_permlane16_swap_b32 v20, v180
    v_permlane16_swap_b32 v21, v181
    v_permlane16_swap_b32 v22, v182
    v_permlane16_swap_b32 v23, v183
    v_permlane16_swap_b32 v24, v184
    v_permlane16_swap_b32 v25, v185
    v_permlane16_swap_b32 v26, v186
    v_permlane16_swap_b32 v27, v187
    v_permlane16_swap_b32 v28, v188
    v_permlane16_swap_b32 v29, v189
    buffer_load_dwordx4 v19, s[24:27], s11 offen offset:1024 lds
    v_pk_fma_f32 v[30:31], v[20:21], v[216:217], v[180:181] op_sel_hi:[1,0,1]
    v_pk_fma_f32 v[30:31], v[20:21], v[216:217], v[30:31] op_sel:[1,1,0] op_sel_hi:[0,1,1] neg_lo:[1,0,0]
    v_pk_fma_f32 v[32:33], v[22:23], v[218:219], v[182:183] op_sel_hi:[1,0,1]
    v_pk_fma_f32 v[32:33], v[22:23], v[218:219], v[32:33] op_sel:[1,1,0] op_sel_hi:[0,1,1] neg_lo:[1,0,0]
    v_pk_fma_f32 v[34:35], v[24:25], v[220:221], v[184:185] op_sel_hi:[1,0,1]
    v_pk_fma_f32 v[34:35], v[24:25], v[220:221], v[34:35] op_sel:[1,1,0] op_sel_hi:[0,1,1] neg_lo:[1,0,0]
    v_pk_fma_f32 v[36:37], v[26:27], v[222:223], v[186:187] op_sel_hi:[1,0,1]
    v_pk_fma_f32 v[36:37], v[26:27], v[222:223], v[36:37] op_sel:[1,1,0] op_sel_hi:[0,1,1] neg_lo:[1,0,0]
    v_pk_fma_f32 v[38:39], v[28:29], v[224:225], v[188:189] op_sel_hi:[1,0,1]
    v_pk_fma_f32 v[38:39], v[28:29], v[224:225], v[38:39] op_sel:[1,1,0] op_sel_hi:[0,1,1] neg_lo:[1,0,0]
    ds_read_b64 v[216:217], v1 offset:256
    ds_read_b64 v[218:219], v1 offset:1152
    ds_read_b64 v[220:221], v1 offset:2048
    ds_read_b64 v[222:223], v1 offset:2944
    s_add_u32 m0, s9, 36864
    s_add_u32 s11, s62, 40960
    buffer_load_dwordx4 v18, s[24:27], s11 offen lds
    ds_read_b64 v[224:225], v1 offset:3840
    v_mov_b64 v[40:41], v[30:31]
    v_mov_b64 v[42:43], v[32:33]
    v_mov_b64 v[44:45], v[34:35]
    v_mov_b64 v[46:47], v[36:37]
    v_mov_b64 v[48:49], v[38:39]
    v_permlane32_swap_b32 v40, v30
    v_permlane32_swap_b32 v41, v31
    v_permlane32_swap_b32 v42, v32
    v_permlane32_swap_b32 v43, v33
    v_permlane32_swap_b32 v44, v34
    v_permlane32_swap_b32 v45, v35
    v_permlane32_swap_b32 v46, v36
    v_permlane32_swap_b32_e64 v47, v37
    buffer_load_dwordx4 v19, s[24:27], s11 offen offset:1024 lds
    v_permlane32_swap_b32 v48, v38
    v_permlane32_swap_b32 v49, v39
    s_mov_b32 exec_hi, 0
    v_mov_b64 v[40:41], 0
    v_mov_b64 v[42:43], 0
    v_mov_b64 v[44:45], 0
    v_mov_b64 v[46:47], 0
    v_mov_b64 v[48:49], 0
    s_mov_b32 exec_lo, 0xffff
    s_mov_b32 exec_hi, 0xffff
    v_mov_b64 v[20:21], 0
    v_mov_b64 v[22:23], 0
    v_mov_b64 v[24:25], 0
    v_mov_b64 v[26:27], 0
    v_mov_b64_e64 v[28:29], 0
    s_mov_b64 exec, -1
    s_waitcnt lgkmcnt(5)
    v_pk_fma_f32 v[30:31], v[40:41], v[50:51], v[20:21] op_sel_hi:[1,0,1]
    v_pk_fma_f32 v[30:31], v[40:41], v[50:51], v[30:31] op_sel:[1,1,0] op_sel_hi:[0,1,1] neg_lo:[1,0,0]
    v_pk_fma_f32 v[90:91], v[80:81], v[70:71], v[90:91] op_sel_hi:[1,0,1]
    v_pk_fma_f32 v[90:91], v[80:81], v[70:71], v[90:91] op_sel:[1,1,0] op_sel_hi:[0,1,1] neg_lo:[1,0,0]
    v_pk_fma_f32 v[32:33], v[42:43], v[52:53], v[22:23] op_sel_hi:[1,0,1]
    v_pk_fma_f32 v[32:33], v[42:43], v[52:53], v[32:33] op_sel:[1,1,0] op_sel_hi:[0,1,1] neg_lo:[1,0,0]
    v_pk_fma_f32 v[92:93], v[82:83], v[72:73], v[92:93] op_sel_hi:[1,0,1]
    v_pk_fma_f32 v[92:93], v[82:83], v[72:73], v[92:93] op_sel:[1,1,0] op_sel_hi:[0,1,1] neg_lo:[1,0,0]
    v_pk_fma_f32 v[34:35], v[44:45], v[54:55], v[24:25] op_sel_hi:[1,0,1]
    v_pk_fma_f32 v[34:35], v[44:45], v[54:55], v[34:35] op_sel:[1,1,0] op_sel_hi:[0,1,1] neg_lo:[1,0,0]
    v_pk_fma_f32 v[94:95], v[84:85], v[74:75], v[94:95] op_sel_hi:[1,0,1]
    v_pk_fma_f32 v[94:95], v[84:85], v[74:75], v[94:95] op_sel:[1,1,0] op_sel_hi:[0,1,1] neg_lo:[1,0,0]
    s_add_u32 m0, s9, 38912
    s_add_u32 s11, s62, 61440
    buffer_load_dwordx4 v18, s[24:27], s11 offen lds
    v_pk_fma_f32 v[36:37], v[46:47], v[56:57], v[26:27] op_sel_hi:[1,0,1]
    v_pk_fma_f32 v[36:37], v[46:47], v[56:57], v[36:37] op_sel:[1,1,0] op_sel_hi:[0,1,1] neg_lo:[1,0,0]
    v_pk_fma_f32 v[96:97], v[86:87], v[76:77], v[96:97] op_sel_hi:[1,0,1]
    v_pk_fma_f32 v[96:97], v[86:87], v[76:77], v[96:97] op_sel:[1,1,0] op_sel_hi:[0,1,1] neg_lo:[1,0,0]
    v_pk_fma_f32 v[38:39], v[48:49], v[58:59], v[28:29] op_sel_hi:[1,0,1]
    v_pk_fma_f32 v[38:39], v[48:49], v[58:59], v[38:39] op_sel:[1,1,0] op_sel_hi:[0,1,1] neg_lo:[1,0,0]
    v_pk_fma_f32 v[98:99], v[88:89], v[78:79], v[98:99] op_sel_hi:[1,0,1]
    v_pk_fma_f32 v[98:99], v[88:89], v[78:79], v[98:99] op_sel:[1,1,0] op_sel_hi:[0,1,1] neg_lo:[1,0,0]
    v_mov_b64 v[40:41], 0
    v_mov_b64 v[42:43], 0
    v_mov_b64 v[44:45], 0
    v_mov_b64 v[46:47], 0
    v_mov_b64 v[48:49], 0
    v_mov_b64 v[50:51], 0
    buffer_load_dwordx4 v19, s[24:27], s11 offen offset:1024 lds
    v_mov_b64 v[52:53], 0
    v_mov_b64 v[54:55], 0
    v_mov_b64 v[56:57], 0
    v_mov_b64 v[58:59], 0
    s_add_u32 m0, s9, 40960
    s_add_u32 s11, s62, 81920
    buffer_load_dwordx4 v18, s[24:27], s11 offen lds
    s_mov_b32 s3, 20000
    s_mov_b64 exec, s[58:59]
    s_cbranch_execz L_g0
    buffer_load_dwordx4 v[40:43], v17, s[32:35], s29 offen offset:0 sc1
    buffer_load_dwordx4 v[44:47], v17, s[32:35], s29 offen offset:256 sc1
    buffer_load_dwordx4 v[48:51], v17, s[32:35], s29 offen offset:512 sc1
    buffer_load_dwordx4 v[52:55], v17, s[32:35], s29 offen offset:768 sc1
    buffer_load_dwordx4 v[56:59], v17, s[32:35], s29 offen offset:1024 sc1
L_g0:
    s_mov_b64 exec, -1
    ds_read_b64 v[20:21], v226 offset:0
    ds_read_b64 v[22:23], v226 offset:128
    ds_read_b64 v[24:25], v226 offset:256
    ds_read_b64 v[26:27], v226 offset:384
    ds_read_b64 v[28:29], v226 offset:512
    ds_read_b64 v[80:81], v227 offset:0
    buffer_load_dwordx4 v19, s[24:27], s11 offen offset:1024 lds
    ds_read_b64 v[82:83], v227 offset:128
    ds_read_b64 v[84:85], v227 offset:256
    ds_read_b64 v[86:87], v227 offset:384
    ds_read_b64 v[88:89], v227 offset:512
    s_waitcnt lgkmcnt(10)
    v_pk_fma_f32 v[216:217], v[90:91], v[70:71], v[216:217] op_sel_hi:[1,0,1]
    v_pk_fma_f32 v[216:217], v[90:91], v[70:71], v[216:217] op_sel:[1,1,0] op_sel_hi:[0,1,1] neg_lo:[1,0,0]
    v_pk_fma_f32 v[218:219], v[92:93], v[72:73], v[218:219] op_sel_hi:[1,0,1]
    v_pk_fma_f32 v[218:219], v[92:93], v[72:73], v[218:219] op_sel:[1,1,0] op_sel_hi:[0,1,1] neg_lo:[1,0,0]
    v_pk_fma_f32 v[220:221], v[94:95], v[74:75], v[220:221] op_sel_hi:[1,0,1]
    v_pk_fma_f32 v[220:221], v[94:95], v[74:75], v[220:221] op_sel:[1,1,0] op_sel_hi:[0,1,1] neg_lo:[1,0,0]
    s_add_u32 m0, s9, 43008
    s_add_u32 s11, s63, 0
    buffer_load_dwordx4 v18, s[24:27], s11 offen lds
    v_pk_fma_f32 v[222:223], v[96:97], v[76:77], v[222:223] op_sel_hi:[1,0,1]
    v_pk_fma_f32 v[222:223], v[96:97], v[76:77], v[222:223] op_sel:[1,1,0] op_sel_hi:[0,1,1] neg_lo:[1,0,0]
    v_pk_fma_f32 v[224:225], v[98:99], v[78:79], v[224:225] op_sel_hi:[1,0,1]
    v_pk_fma_f32 v[224:225], v[98:99], v[78:79], v[224:225] op_sel:[1,1,0] op_sel_hi:[0,1,1] neg_lo:[1,0,0]
    ds_read_b64 v[90:91], v229 offset:0
    ds_read_b64 v[92:93], v229 offset:128
    ds_read_b64 v[94:95], v229 offset:256
    ds_read_b64 v[96:97], v229 offset:384
    ds_read_b64 v[98:99], v229 offset:512
    v_pk_fma_f32 v[30:31], v[216:217], v[60:61], v[30:31] op_sel_hi:[1,0,1]
    buffer_load_dwordx4 v19, s[24:27], s11 offen offset:1024 lds
    v_pk_fma_f32 v[30:31], v[216:217], v[60:61], v[30:31] op_sel:[1,1,0] op_sel_hi:[0,1,1] neg_lo:[1,0,0]
    v_pk_mul_f32 v[180:181], v[30:31], v[206:207] op_sel_hi:[1,0]
    v_pk_fma_f32 v[180:181], v[30:31], v[206:207], v[180:181] op_sel:[1,1,0] op_sel_hi:[0,1,1] neg_lo:[1,0,0]
    v_pk_fma_f32 v[32:33], v[218:219], v[62:63], v[32:33] op_sel_hi:[1,0,1]
    v_pk_fma_f32 v[32:33], v[218:219], v[62:63], v[32:33] op_sel:[1,1,0] op_sel_hi:[0,1,1] neg_lo:[1,0,0]
    v_pk_mul_f32 v[182:183], v[32:33], v[208:209] op_sel_hi:[1,0]
    v_pk_fma_f32 v[182:183], v[32:33], v[208:209], v[182:183] op_sel:[1,1,0] op_sel_hi:[0,1,1] neg_lo:[1,0,0]
    v_pk_fma_f32 v[34:35], v[220:221], v[64:65], v[34:35] op_sel_hi:[1,0,1]
    v_pk_fma_f32 v[34:35], v[220:221], v[64:65], v[34:35] op_sel:[1,1,0] op_sel_hi:[0,1,1] neg_lo:[1,0,0]
    v_pk_mul_f32 v[184:185], v[34:35], v[210:211] op_sel_hi:[1,0]
    v_pk_fma_f32 v[184:185], v[34:35], v[210:211], v[184:185] op_sel:[1,1,0] op_sel_hi:[0,1,1] neg_lo:[1,0,0]
    v_pk_fma_f32 v[36:37], v[222:223], v[66:67], v[36:37] op_sel_hi:[1,0,1]
    v_pk_fma_f32 v[36:37], v[222:223], v[66:67], v[36:37] op_sel:[1,1,0] op_sel_hi:[0,1,1] neg_lo:[1,0,0]
    v_pk_mul_f32 v[186:187], v[36:37], v[212:213] op_sel_hi:[1,0]
    v_pk_fma_f32 v[186:187], v[36:37], v[212:213], v[186:187] op_sel:[1,1,0] op_sel_hi:[0,1,1] neg_lo:[1,0,0]
    v_pk_fma_f32 v[38:39], v[224:225], v[68:69], v[38:39] op_sel_hi:[1,0,1]
    v_pk_fma_f32 v[38:39], v[224:225], v[68:69], v[38:39] op_sel:[1,1,0] op_sel_hi:[0,1,1] neg_lo:[1,0,0]
    v_pk_mul_f32 v[188:189], v[38:39], v[214:215] op_sel_hi:[1,0]
    v_pk_fma_f32 v[188:189], v[38:39], v[214:215], v[188:189] op_sel:[1,1,0] op_sel_hi:[0,1,1] neg_lo:[1,0,0]
    s_waitcnt lgkmcnt(5)
    v_pk_mul_f32 v[232:233], v[20:21], v[80:81] op_sel_hi:[1,0]
    v_pk_fma_f32 v[232:233], v[20:21], v[80:81], v[232:233] op_sel:[1,1,0] op_sel_hi:[0,1,1] neg_lo:[1,0,0]
    v_pk_mul_f32 v[234:235], v[22:23], v[82:83] op_sel_hi:[1,0]
    v_pk_fma_f32 v[234:235], v[22:23], v[82:83], v[234:235] op_sel:[1,1,0] op_sel_hi:[0,1,1] neg_lo:[1,0,0]
    v_pk_mul_f32 v[236:237], v[24:25], v[84:85] op_sel_hi:[1,0]
    v_pk_fma_f32 v[236:237], v[24:25], v[84:85], v[236:237] op_sel:[1,1,0] op_sel_hi:[0,1,1] neg_lo:[1,0,0]
    v_pk_mul_f32 v[238:239], v[26:27], v[86:87] op_sel_hi:[1,0]
    v_pk_fma_f32 v[238:239], v[26:27], v[86:87], v[238:239] op_sel:[1,1,0] op_sel_hi:[0,1,1] neg_lo:[1,0,0]
    v_pk_mul_f32 v[240:241], v[28:29], v[88:89] op_sel_hi:[1,0]
    v_pk_fma_f32 v[240:241], v[28:29], v[88:89], v[240:241] op_sel:[1,1,0] op_sel_hi:[0,1,1] neg_lo:[1,0,0]
    s_waitcnt lgkmcnt(0)
    v_pk_mul_f32 v[20:21], v[60:61], v[90:91] op_sel_hi:[1,0]
    v_pk_fma_f32 v[20:21], v[60:61], v[90:91], v[20:21] op_sel:[1,1,0] op_sel_hi:[0,1,1] neg_lo:[1,0,0]
    v_pk_mul_f32 v[216:217], v[20:21], v[206:207] op_sel_hi:[1,0]
    v_pk_fma_f32 v[216:217], v[20:21], v[206:207], v[216:217] op_sel:[1,1,0] op_sel_hi:[0,1,1] neg_lo:[1,0,0]
    v_pk_mul_f32 v[22:23], v[62:63], v[92:93] op_sel_hi:[1,0]
    v_pk_fma_f32 v[22:23], v[62:63], v[92:93], v[22:23] op_sel:[1,1,0] op_sel_hi:[0,1,1] neg_lo:[1,0,0]
    v_pk_mul_f32 v[218:219], v[22:23], v[208:209] op_sel_hi:[1,0]
    v_pk_fma_f32 v[218:219], v[22:23], v[208:209], v[218:219] op_sel:[1,1,0] op_sel_hi:[0,1,1] neg_lo:[1,0,0]
    v_pk_mul_f32 v[24:25], v[64:65], v[94:95] op_sel_hi:[1,0]
    v_pk_fma_f32 v[24:25], v[64:65], v[94:95], v[24:25] op_sel:[1,1,0] op_sel_hi:[0,1,1] neg_lo:[1,0,0]
    v_pk_mul_f32 v[220:221], v[24:25], v[210:211] op_sel_hi:[1,0]
    v_pk_fma_f32 v[220:221], v[24:25], v[210:211], v[220:221] op_sel:[1,1,0] op_sel_hi:[0,1,1] neg_lo:[1,0,0]
    v_pk_mul_f32 v[26:27], v[66:67], v[96:97] op_sel_hi:[1,0]
    v_pk_fma_f32 v[26:27], v[66:67], v[96:97], v[26:27] op_sel:[1,1,0] op_sel_hi:[0,1,1] neg_lo:[1,0,0]
    v_pk_mul_f32 v[222:223], v[26:27], v[212:213] op_sel_hi:[1,0]
    v_pk_fma_f32 v[222:223], v[26:27], v[212:213], v[222:223] op_sel:[1,1,0] op_sel_hi:[0,1,1] neg_lo:[1,0,0]
    v_pk_mul_f32 v[28:29], v[68:69], v[98:99] op_sel_hi:[1,0]
    v_pk_fma_f32 v[28:29], v[68:69], v[98:99], v[28:29] op_sel:[1,1,0] op_sel_hi:[0,1,1] neg_lo:[1,0,0]
    v_pk_mul_f32 v[224:225], v[28:29], v[214:215] op_sel_hi:[1,0]
    v_pk_fma_f32 v[224:225], v[28:29], v[214:215], v[224:225] op_sel:[1,1,0] op_sel_hi:[0,1,1] neg_lo:[1,0,0]
    s_lshl_b32 s12, s4, 4
    s_add_u32 s12, s12, s5
    s_lshl_b32 s12, s12, 2
    s_add_u32 s12, s12, s8
    s_lshl_b32 s12, s12, 1
    v_bfe_u32 v96, v0, 5, 1
    v_add_u32_e64 v96, s12, v96
    v_mul_u32_u24 v96, 1280, v96
    v_and_b32_e64 v97, 31, v0
    v_lshl_add_u32 v98, v97, 4, v96
    v_lshl_add_u32 v99, v97, 3, v96
    global_load_dwordx4 v[70:73], v98, s[40:41]
    global_load_dwordx4 v[74:77], v98, s[40:41] offset:512
    global_load_dwordx2 v[78:79], v99, s[40:41] offset:1024
    v_lshlrev_b32_e64 v98, 4, v97
    v_add_u32 v98, 162176, v98
    v_lshlrev_b32_e64 v99, 3, v97
    v_add_u32 v99, 163200, v99
    ds_read_b128 v[80:83], v98
    ds_read_b128 v[84:87], v98 offset:512
    ds_read_b64 v[88:89], v99
    s_lshl_b32 s12, s4, 1
    s_add_u32 s12, s12, s7
    s_lshl_b32 s12, s12, 2
    s_add_u32 s12, s12, s6
    s_lshl_b32 s12, s12, 4
    s_and_b32 s13, s5, 7
    s_mul_i32 s13, s13, 80
    v_bfe_u32 v96, v0, 2, 4
    v_and_b32 v97, 3, v0
    v_add_u32 v96, s12, v96
    v_mul_u32_u24 v96, 640, v96
    v_lshl_add_u32 v97, v97, 2, s13
    v_add_lshl_u32 v231, v96, v97, 1
    global_load_dwordx2 v[190:191], v231, s[40:41] offset:0
    global_load_dwordx2 v[192:193], v231, s[40:41] offset:32
    global_load_dwordx2 v[194:195], v231, s[40:41] offset:64
    global_load_dwordx2 v[92:93], v231, s[40:41] offset:96
    global_load_dwordx2 v[94:95], v231, s[40:41] offset:128
    s_waitcnt vmcnt(39)
    ds_read_b128 a[0:3], v12 offset:0
    ds_read_b128 a[4:7], v13 offset:0
    s_waitcnt vmcnt(37)
    ds_read_b128 a[8:11], v12 offset:2048
    ds_read_b128 a[12:15], v13 offset:2048
    s_waitcnt vmcnt(35)
    ds_read_b128 a[16:19], v12 offset:4096
    ds_read_b128 a[20:23], v13 offset:4096
    s_waitcnt vmcnt(33)
    ds_read_b128 a[24:27], v12 offset:6144
    ds_read_b128 a[28:31], v13 offset:6144
    s_waitcnt vmcnt(31)
    ds_read_b128 a[32:35], v12 offset:36864
    ds_read_b128 a[36:39], v13 offset:36864
    s_waitcnt vmcnt(29)
    ds_read_b128 a[40:43], v12 offset:38912
    ds_read_b128 a[44:47], v13 offset:38912
    s_waitcnt vmcnt(27)
    ds_read_b128 a[48:51], v12 offset:40960
    ds_read_b128 a[52:55], v13 offset:40960
    s_waitcnt vmcnt(24)
    ds_read_b128 a[56:59], v12 offset:43008
    ds_read_b128 a[60:63], v13 offset:43008
    s_waitcnt vmcnt(22)
    ds_read_b128 a[64:67], v10 offset:0
    ds_read_b128 a[68:71], v11 offset:0
    s_waitcnt vmcnt(20)
    ds_read_b128 a[72:75], v10 offset:2048
    ds_read_b128 a[76:79], v11 offset:2048
    s_waitcnt vmcnt(18)
    ds_read_b128 a[80:83], v10 offset:4096
    ds_read_b128 a[84:87], v11 offset:4096
    s_waitcnt vmcnt(16)
    ds_read_b128 a[88:91], v10 offset:6144
    ds_read_b128 a[92:95], v11 offset:6144
    s_waitcnt vmcnt(14)
    ds_read_b128 a[96:99], v10 offset:36864
    ds_read_b128 a[100:103], v11 offset:36864
    s_waitcnt vmcnt(11)
    s_mov_b64 exec, s[58:59]
    s_cbranch_execz L_got
    v_min3_u32 v246, v41, v43, v45
    v_max3_u32 v247, v41, v43, v45
    v_min3_u32 v246, v246, v47, v49
    v_max3_u32 v247, v247, v47, v49
    v_min3_u32 v246, v246, v51, v53
    v_max3_u32 v247, v247, v51, v53
    v_min3_u32 v246, v246, v55, v57
    v_max3_u32 v247, v247, v55, v57
    v_min_u32 v246, v246, v59
    v_max_u32 v247, v247, v59
    v_cmp_ne_u32_e64 vcc, s10, v246
    v_cmp_ne_u32 s[14:15], s10, v247
    s_or_b64 vcc, vcc, s[14:15]
    s_cbranch_vccz L_got
L_poll1:
    buffer_load_dwordx4 v[40:43], v17, s[32:35], s29 offen offset:0 sc1
    buffer_load_dwordx4 v[44:47], v17, s[32:35], s29 offen offset:256 sc1
    buffer_load_dwordx4 v[48:51], v17, s[32:35], s29 offen offset:512 sc1
    buffer_load_dwordx4 v[52:55], v17, s[32:35], s29 offen offset:768 sc1
    buffer_load_dwordx4 v[56:59], v17, s[32:35], s29 offen offset:1024 sc1
    s_sub_u32 s3, s3, 1
    s_waitcnt vmcnt(0)
    v_min3_u32 v246, v41, v43, v45
    v_max3_u32 v247, v41, v43, v45
    v_min3_u32 v246, v246, v47, v49
    v_max3_u32 v247, v247, v47, v49
    v_min3_u32 v246, v246, v51, v53
    v_max3_u32 v247, v247, v51, v53
    v_min3_u32 v246, v246, v55, v57
    v_max3_u32 v247, v247, v55, v57
    v_min_u32 v246, v246, v59
    v_max_u32 v247, v247, v59
    v_cmp_ne_u32_e64 vcc, s10, v246
    v_cmp_ne_u32 s[14:15], s10, v247
    s_or_b64 vcc, vcc, s[14:15]
    s_cmp_eq_u32 s3, 0
    s_cbranch_scc1 L_got
    s_cbranch_vccnz L_poll1
L_got:
    s_mov_b64 exec, -1
    v_pk_mul_f32 v[60:61], v[232:233], v[40:41] op_sel_hi:[1,0]
    v_pk_fma_f32 v[60:61], v[232:233], v[42:43], v[60:61] op_sel:[1,0,0] op_sel_hi:[0,0,1] neg_lo:[1,0,0]
    v_pk_mul_f32 v[62:63], v[234:235], v[44:45] op_sel_hi:[1,0]
    v_pk_fma_f32 v[62:63], v[234:235], v[46:47], v[62:63] op_sel:[1,0,0] op_sel_hi:[0,0,1] neg_lo:[1,0,0]
    v_pk_mul_f32 v[64:65], v[236:237], v[48:49] op_sel_hi:[1,0]
    v_pk_fma_f32 v[64:65], v[236:237], v[50:51], v[64:65] op_sel:[1,0,0] op_sel_hi:[0,0,1] neg_lo:[1,0,0]
    v_pk_mul_f32 v[66:67], v[238:239], v[52:53] op_sel_hi:[1,0]
    v_pk_fma_f32 v[66:67], v[238:239], v[54:55], v[66:67] op_sel:[1,0,0] op_sel_hi:[0,0,1] neg_lo:[1,0,0]
    v_pk_mul_f32 v[68:69], v[240:241], v[56:57] op_sel_hi:[1,0]
    v_pk_fma_f32 v[68:69], v[240:241], v[58:59], v[68:69] op_sel:[1,0,0] op_sel_hi:[0,0,1] neg_lo:[1,0,0]
    v_permlane32_swap_b32 v60, v61
    v_permlane32_swap_b32 v62, v63
    v_permlane32_swap_b32 v64, v65
    v_permlane32_swap_b32 v66, v67
    v_permlane32_swap_b32 v68, v69
    v_add_f32 v68, v68, v69
    v_add_f32 v60, v60, v61
    v_mov_b32 v69, v68
    v_add_f32 v62, v62, v63
    v_add_f32 v64, v64, v65
    v_add_f32 v66, v66, v67
    v_permlane16_swap_b32 v68, v69
    v_permlane16_swap_b32 v60, v62
    v_permlane16_swap_b32 v64, v66
    v_add_f32 v68, v68, v69
    v_add_f32 v60, v60, v62
    v_add_f32 v64, v64, v66
    ds_write_b32 v15, v68 offset:2048
    ds_write_b32 v14, v60
    ds_write_b32 v14, v64 offset:1024
    ds_read_b128 a[104:107], v10 offset:38912
    ds_read_b128 a[108:111], v11 offset:38912
    s_waitcnt vmcnt(10)
    ds_read_b128 a[112:115], v10 offset:40960
    ds_read_b128 a[116:119], v11 offset:40960
    s_waitcnt vmcnt(8)
    ds_read_b128 a[120:123], v10 offset:43008
    ds_read_b128 a[124:127], v11 offset:43008
    s_waitcnt lgkmcnt(0)
    s_barrier
    ds_read_b128 v[20:23], v16 offset:0
    ds_read_b128 v[24:27], v16 offset:256
    ds_read_b128 v[28:31], v16 offset:512
    ds_read_b128 v[32:35], v16 offset:768
    ds_read_b128 v[36:39], v16 offset:1024
    ds_read_b128 v[40:43], v16 offset:1280
    ds_read_b128 v[44:47], v16 offset:1536
    ds_read_b128 v[48:51], v16 offset:1792
    ds_read_b128 v[52:55], v16 offset:2048
    ds_read_b128 v[56:59], v16 offset:2304
    s_waitcnt lgkmcnt(8)
    v_pk_add_f32 v[20:21], v[20:21], v[22:23]
    v_pk_add_f32 v[24:25], v[24:25], v[26:27]
    v_pk_add_f32 v[20:21], v[20:21], v[24:25]
    v_pk_fma_f32 v[180:181], v[20:21], v[216:217], v[180:181] op_sel_hi:[1,0,1]
    v_pk_fma_f32 v[180:181], v[20:21], v[216:217], v[180:181] op_sel:[1,1,0] op_sel_hi:[0,1,1] neg_lo:[1,0,0]
    v_pk_fma_f32 v[100:101], v[180:181], v[196:197], v[100:101] op_sel_hi:[1,0,1]
    v_pk_fma_f32 v[100:101], v[180:181], v[196:197], v[100:101] op_sel:[1,1,0] op_sel_hi:[0,1,1] neg_lo:[1,0,0]
    v_pk_fma_f32 v[102:103], v[100:101], v[196:197], v[102:103] op_sel_hi:[1,0,1]
    v_pk_fma_f32 v[102:103], v[100:101], v[196:197], v[102:103] op_sel:[1,1,0] op_sel_hi:[0,1,1] neg_lo:[1,0,0]
    v_pk_fma_f32 v[104:105], v[102:103], v[196:197], v[104:105] op_sel_hi:[1,0,1]
    v_pk_fma_f32 v[104:105], v[102:103], v[196:197], v[104:105] op_sel:[1,1,0] op_sel_hi:[0,1,1] neg_lo:[1,0,0]
    v_pk_fma_f32 v[106:107], v[104:105], v[196:197], v[106:107] op_sel_hi:[1,0,1]
    v_pk_fma_f32 v[106:107], v[104:105], v[196:197], v[106:107] op_sel:[1,1,0] op_sel_hi:[0,1,1] neg_lo:[1,0,0]
    v_pk_fma_f32 v[108:109], v[106:107], v[196:197], v[108:109] op_sel_hi:[1,0,1]
    v_pk_fma_f32 v[108:109], v[106:107], v[196:197], v[108:109] op_sel:[1,1,0] op_sel_hi:[0,1,1] neg_lo:[1,0,0]
    v_pk_fma_f32 v[110:111], v[108:109], v[196:197], v[110:111] op_sel_hi:[1,0,1]
    v_pk_fma_f32 v[110:111], v[108:109], v[196:197], v[110:111] op_sel:[1,1,0] op_sel_hi:[0,1,1] neg_lo:[1,0,0]
    v_pk_fma_f32 v[112:113], v[110:111], v[196:197], v[112:113] op_sel_hi:[1,0,1]
    v_pk_fma_f32 v[112:113], v[110:111], v[196:197], v[112:113] op_sel:[1,1,0] op_sel_hi:[0,1,1] neg_lo:[1,0,0]
    v_pk_fma_f32 v[114:115], v[112:113], v[196:197], v[114:115] op_sel_hi:[1,0,1]
    v_pk_fma_f32 v[114:115], v[112:113], v[196:197], v[114:115] op_sel:[1,1,0] op_sel_hi:[0,1,1] neg_lo:[1,0,0]
    v_cvt_pk_bf16_f32 v20, v100, v102
    v_cvt_pk_bf16_f32 v21, v104, v106
    v_cvt_pk_bf16_f32 v22, v108, v110
    v_cvt_pk_bf16_f32 v23, v112, v114
    ds_write_b128 v5, v[20:23] offset:36864
    ds_read_b64_tr_b16 v[20:21], v244 offset:36864
    ds_read_b64_tr_b16 v[22:23], v245 offset:36864
    v_cvt_pk_bf16_f32 v24, -v101, -v103
    v_cvt_pk_bf16_f32 v25, -v105, -v107
    v_cvt_pk_bf16_f32 v26, -v109, -v111
    v_cvt_pk_bf16_f32 v27, -v113, -v115
    ds_write_b128 v5, v[24:27] offset:37888
    ds_read_b64_tr_b16 v[24:25], v244 offset:37888
    ds_read_b64_tr_b16 v[26:27], v245 offset:37888
    s_waitcnt lgkmcnt(12)
    v_pk_add_f32 v[28:29], v[28:29], v[30:31]
    v_pk_add_f32 v[32:33], v[32:33], v[34:35]
    v_pk_add_f32 v[28:29], v[28:29], v[32:33]
    v_pk_fma_f32 v[182:183], v[28:29], v[218:219], v[182:183] op_sel_hi:[1,0,1]
    v_pk_fma_f32 v[182:183], v[28:29], v[218:219], v[182:183] op_sel:[1,1,0] op_sel_hi:[0,1,1] neg_lo:[1,0,0]
    v_pk_fma_f32 v[116:117], v[182:183], v[198:199], v[116:117] op_sel_hi:[1,0,1]
    v_pk_fma_f32 v[116:117], v[182:183], v[198:199], v[116:117] op_sel:[1,1,0] op_sel_hi:[0,1,1] neg_lo:[1,0,0]
    v_pk_fma_f32 v[118:119], v[116:117], v[198:199], v[118:119] op_sel_hi:[1,0,1]
    v_pk_fma_f32 v[118:119], v[116:117], v[198:199], v[118:119] op_sel:[1,1,0] op_sel_hi:[0,1,1] neg_lo:[1,0,0]
    v_pk_fma_f32 v[120:121], v[118:119], v[198:199], v[120:121] op_sel_hi:[1,0,1]
    v_pk_fma_f32 v[120:121], v[118:119], v[198:199], v[120:121] op_sel:[1,1,0] op_sel_hi:[0,1,1] neg_lo:[1,0,0]
    s_waitcnt lgkmcnt(3)
    buffer_store_dwordx4 v[20:23], v243, s[32:35], s30 offen offset:0 sc1
    s_waitcnt lgkmcnt(0)
    buffer_store_dwordx4 v[24:27], v243, s[32:35], s31 offen offset:0 sc1
    v_pk_fma_f32 v[122:123], v[120:121], v[198:199], v[122:123] op_sel_hi:[1,0,1]
    v_pk_fma_f32 v[122:123], v[120:121], v[198:199], v[122:123] op_sel:[1,1,0] op_sel_hi:[0,1,1] neg_lo:[1,0,0]
    v_pk_fma_f32 v[124:125], v[122:123], v[198:199], v[124:125] op_sel_hi:[1,0,1]
    v_pk_fma_f32 v[124:125], v[122:123], v[198:199], v[124:125] op_sel:[1,1,0] op_sel_hi:[0,1,1] neg_lo:[1,0,0]
    v_pk_fma_f32 v[126:127], v[124:125], v[198:199], v[126:127] op_sel_hi:[1,0,1]
    v_pk_fma_f32 v[126:127], v[124:125], v[198:199], v[126:127] op_sel:[1,1,0] op_sel_hi:[0,1,1] neg_lo:[1,0,0]
    v_pk_fma_f32 v[128:129], v[126:127], v[198:199], v[128:129] op_sel_hi:[1,0,1]
    v_pk_fma_f32 v[128:129], v[126:127], v[198:199], v[128:129] op_sel:[1,1,0] op_sel_hi:[0,1,1] neg_lo:[1,0,0]
    v_pk_fma_f32 v[130:131], v[128:129], v[198:199], v[130:131] op_sel_hi:[1,0,1]
    v_pk_fma_f32 v[130:131], v[128:129], v[198:199], v[130:131] op_sel:[1,1,0] op_sel_hi:[0,1,1] neg_lo:[1,0,0]
    v_cvt_pk_bf16_f32 v28, v116, v118
    v_cvt_pk_bf16_f32 v29, v120, v122
    v_cvt_pk_bf16_f32 v30, v124, v126
    v_cvt_pk_bf16_f32 v31, v128, v130
    ds_write_b128 v5, v[28:31] offset:38912
    ds_read_b64_tr_b16 v[28:29], v244 offset:38912
    ds_read_b64_tr_b16 v[30:31], v245 offset:38912
    v_cvt_pk_bf16_f32 v32, -v117, -v119
    v_cvt_pk_bf16_f32 v33, -v121, -v123
    v_cvt_pk_bf16_f32 v34, -v125, -v127
    v_cvt_pk_bf16_f32 v35, -v129, -v131
    ds_write_b128 v5, v[32:35] offset:39936
    ds_read_b64_tr_b16 v[32:33], v244 offset:39936
    ds_read_b64_tr_b16 v[34:35], v245 offset:39936
    v_pk_add_f32 v[36:37], v[36:37], v[38:39]
    v_pk_add_f32 v[40:41], v[40:41], v[42:43]
    v_pk_add_f32 v[36:37], v[36:37], v[40:41]
    v_pk_fma_f32 v[184:185], v[36:37], v[220:221], v[184:185] op_sel_hi:[1,0,1]
    v_pk_fma_f32 v[184:185], v[36:37], v[220:221], v[184:185] op_sel:[1,1,0] op_sel_hi:[0,1,1] neg_lo:[1,0,0]
    v_pk_fma_f32 v[132:133], v[184:185], v[200:201], v[132:133] op_sel_hi:[1,0,1]
    v_pk_fma_f32 v[132:133], v[184:185], v[200:201], v[132:133] op_sel:[1,1,0] op_sel_hi:[0,1,1] neg_lo:[1,0,0]
    v_pk_fma_f32 v[134:135], v[132:133], v[200:201], v[134:135] op_sel_hi:[1,0,1]
    v_pk_fma_f32 v[134:135], v[132:133], v[200:201], v[134:135] op_sel:[1,1,0] op_sel_hi:[0,1,1] neg_lo:[1,0,0]
    v_pk_fma_f32 v[136:137], v[134:135], v[200:201], v[136:137] op_sel_hi:[1,0,1]
    v_pk_fma_f32 v[136:137], v[134:135], v[200:201], v[136:137] op_sel:[1,1,0] op_sel_hi:[0,1,1] neg_lo:[1,0,0]
    s_waitcnt lgkmcnt(3)
    buffer_store_dwordx4 v[28:31], v243, s[32:35], s30 offen offset:512 sc1
    s_waitcnt lgkmcnt(0)
    buffer_store_dwordx4 v[32:35], v243, s[32:35], s31 offen offset:512 sc1
    v_pk_fma_f32 v[138:139], v[136:137], v[200:201], v[138:139] op_sel_hi:[1,0,1]
    v_pk_fma_f32 v[138:139], v[136:137], v[200:201], v[138:139] op_sel:[1,1,0] op_sel_hi:[0,1,1] neg_lo:[1,0,0]
    v_pk_fma_f32 v[140:141], v[138:139], v[200:201], v[140:141] op_sel_hi:[1,0,1]
    v_pk_fma_f32 v[140:141], v[138:139], v[200:201], v[140:141] op_sel:[1,1,0] op_sel_hi:[0,1,1] neg_lo:[1,0,0]
    v_pk_fma_f32 v[142:143], v[140:141], v[200:201], v[142:143] op_sel_hi:[1,0,1]
    v_pk_fma_f32 v[142:143], v[140:141], v[200:201], v[142:143] op_sel:[1,1,0] op_sel_hi:[0,1,1] neg_lo:[1,0,0]
    v_pk_fma_f32 v[144:145], v[142:143], v[200:201], v[144:145] op_sel_hi:[1,0,1]
    v_pk_fma_f32 v[144:145], v[142:143], v[200:201], v[144:145] op_sel:[1,1,0] op_sel_hi:[0,1,1] neg_lo:[1,0,0]
    v_pk_fma_f32 v[146:147], v[144:145], v[200:201], v[146:147] op_sel_hi:[1,0,1]
    v_pk_fma_f32 v[146:147], v[144:145], v[200:201], v[146:147] op_sel:[1,1,0] op_sel_hi:[0,1,1] neg_lo:[1,0,0]
    v_cvt_pk_bf16_f32 v36, v132, v134
    v_cvt_pk_bf16_f32 v37, v136, v138
    v_cvt_pk_bf16_f32 v38, v140, v142
    v_cvt_pk_bf16_f32 v39, v144, v146
    ds_write_b128 v5, v[36:39] offset:40960
    ds_read_b64_tr_b16 v[36:37], v244 offset:40960
    ds_read_b64_tr_b16 v[38:39], v245 offset:40960
    v_cvt_pk_bf16_f32 v40, -v133, -v135
    v_cvt_pk_bf16_f32 v41, -v137, -v139
    v_cvt_pk_bf16_f32 v42, -v141, -v143
    v_cvt_pk_bf16_f32 v43, -v145, -v147
    ds_write_b128 v5, v[40:43] offset:41984
    ds_read_b64_tr_b16 v[40:41], v244 offset:41984
    ds_read_b64_tr_b16 v[42:43], v245 offset:41984
    v_pk_add_f32 v[44:45], v[44:45], v[46:47]
    v_pk_add_f32 v[48:49], v[48:49], v[50:51]
    v_pk_add_f32 v[44:45], v[44:45], v[48:49]
    v_pk_fma_f32 v[186:187], v[44:45], v[222:223], v[186:187] op_sel_hi:[1,0,1]
    v_pk_fma_f32 v[186:187], v[44:45], v[222:223], v[186:187] op_sel:[1,1,0] op_sel_hi:[0,1,1] neg_lo:[1,0,0]
    v_pk_fma_f32 v[148:149], v[186:187], v[202:203], v[148:149] op_sel_hi:[1,0,1]
    v_pk_fma_f32 v[148:149], v[186:187], v[202:203], v[148:149] op_sel:[1,1,0] op_sel_hi:[0,1,1] neg_lo:[1,0,0]
    v_pk_fma_f32 v[150:151], v[148:149], v[202:203], v[150:151] op_sel_hi:[1,0,1]
    v_pk_fma_f32 v[150:151], v[148:149], v[202:203], v[150:151] op_sel:[1,1,0] op_sel_hi:[0,1,1] neg_lo:[1,0,0]
    v_pk_fma_f32 v[152:153], v[150:151], v[202:203], v[152:153] op_sel_hi:[1,0,1]
    v_pk_fma_f32 v[152:153], v[150:151], v[202:203], v[152:153] op_sel:[1,1,0] op_sel_hi:[0,1,1] neg_lo:[1,0,0]
    s_waitcnt lgkmcnt(3)
    buffer_store_dwordx4 v[36:39], v243, s[32:35], s30 offen offset:1024 sc1
    s_waitcnt lgkmcnt(0)
    buffer_store_dwordx4 v[40:43], v243, s[32:35], s31 offen offset:1024 sc1
    v_pk_fma_f32 v[154:155], v[152:153], v[202:203], v[154:155] op_sel_hi:[1,0,1]
    v_pk_fma_f32 v[154:155], v[152:153], v[202:203], v[154:155] op_sel:[1,1,0] op_sel_hi:[0,1,1] neg_lo:[1,0,0]
    v_pk_fma_f32 v[156:157], v[154:155], v[202:203], v[156:157] op_sel_hi:[1,0,1]
    v_pk_fma_f32 v[156:157], v[154:155], v[202:203], v[156:157] op_sel:[1,1,0] op_sel_hi:[0,1,1] neg_lo:[1,0,0]
    v_pk_fma_f32 v[158:159], v[156:157], v[202:203], v[158:159] op_sel_hi:[1,0,1]
    v_pk_fma_f32 v[158:159], v[156:157], v[202:203], v[158:159] op_sel:[1,1,0] op_sel_hi:[0,1,1] neg_lo:[1,0,0]
    v_pk_fma_f32 v[160:161], v[158:159], v[202:203], v[160:161] op_sel_hi:[1,0,1]
    v_pk_fma_f32 v[160:161], v[158:159], v[202:203], v[160:161] op_sel:[1,1,0] op_sel_hi:[0,1,1] neg_lo:[1,0,0]
    v_pk_fma_f32 v[162:163], v[160:161], v[202:203], v[162:163] op_sel_hi:[1,0,1]
    v_pk_fma_f32 v[162:163], v[160:161], v[202:203], v[162:163] op_sel:[1,1,0] op_sel_hi:[0,1,1] neg_lo:[1,0,0]
    v_cvt_pk_bf16_f32 v44, v148, v150
    v_cvt_pk_bf16_f32 v45, v152, v154
    v_cvt_pk_bf16_f32 v46, v156, v158
    v_cvt_pk_bf16_f32 v47, v160, v162
    ds_write_b128 v5, v[44:47] offset:43008
    ds_read_b64_tr_b16 v[44:45], v244 offset:43008
    ds_read_b64_tr_b16 v[46:47], v245 offset:43008
    v_cvt_pk_bf16_f32 v48, -v149, -v151
    v_cvt_pk_bf16_f32 v49, -v153, -v155
    v_cvt_pk_bf16_f32 v50, -v157, -v159
    v_cvt_pk_bf16_f32 v51, -v161, -v163
    ds_write_b128 v5, v[48:51] offset:44032
    ds_read_b64_tr_b16 v[48:49], v244 offset:44032
    ds_read_b64_tr_b16 v[50:51], v245 offset:44032
    v_pk_add_f32 v[52:53], v[52:53], v[54:55]
    v_pk_add_f32 v[56:57], v[56:57], v[58:59]
    v_pk_add_f32 v[52:53], v[52:53], v[56:57]
    v_pk_fma_f32 v[188:189], v[52:53], v[224:225], v[188:189] op_sel_hi:[1,0,1]
    v_pk_fma_f32 v[188:189], v[52:53], v[224:225], v[188:189] op_sel:[1,1,0] op_sel_hi:[0,1,1] neg_lo:[1,0,0]
    v_pk_fma_f32 v[164:165], v[188:189], v[204:205], v[164:165] op_sel_hi:[1,0,1]
    v_pk_fma_f32 v[164:165], v[188:189], v[204:205], v[164:165] op_sel:[1,1,0] op_sel_hi:[0,1,1] neg_lo:[1,0,0]
    v_pk_fma_f32 v[166:167], v[164:165], v[204:205], v[166:167] op_sel_hi:[1,0,1]
    v_pk_fma_f32 v[166:167], v[164:165], v[204:205], v[166:167] op_sel:[1,1,0] op_sel_hi:[0,1,1] neg_lo:[1,0,0]
    v_pk_fma_f32 v[168:169], v[166:167], v[204:205], v[168:169] op_sel_hi:[1,0,1]
    v_pk_fma_f32 v[168:169], v[166:167], v[204:205], v[168:169] op_sel:[1,1,0] op_sel_hi:[0,1,1] neg_lo:[1,0,0]
    s_waitcnt lgkmcnt(3)
    buffer_store_dwordx4 v[44:47], v243, s[32:35], s30 offen offset:1536 sc1
    s_waitcnt lgkmcnt(0)
    buffer_store_dwordx4 v[48:51], v243, s[32:35], s31 offen offset:1536 sc1
    v_pk_fma_f32 v[170:171], v[168:169], v[204:205], v[170:171] op_sel_hi:[1,0,1]
    v_pk_fma_f32 v[170:171], v[168:169], v[204:205], v[170:171] op_sel:[1,1,0] op_sel_hi:[0,1,1] neg_lo:[1,0,0]
    v_pk_fma_f32 v[172:173], v[170:171], v[204:205], v[172:173] op_sel_hi:[1,0,1]
    v_pk_fma_f32 v[172:173], v[170:171], v[204:205], v[172:173] op_sel:[1,1,0] op_sel_hi:[0,1,1] neg_lo:[1,0,0]
    v_pk_fma_f32 v[174:175], v[172:173], v[204:205], v[174:175] op_sel_hi:[1,0,1]
    v_pk_fma_f32 v[174:175], v[172:173], v[204:205], v[174:175] op_sel:[1,1,0] op_sel_hi:[0,1,1] neg_lo:[1,0,0]
    v_pk_fma_f32 v[176:177], v[174:175], v[204:205], v[176:177] op_sel_hi:[1,0,1]
    v_pk_fma_f32 v[176:177], v[174:175], v[204:205], v[176:177] op_sel:[1,1,0] op_sel_hi:[0,1,1] neg_lo:[1,0,0]
    v_pk_fma_f32 v[178:179], v[176:177], v[204:205], v[178:179] op_sel_hi:[1,0,1]
    v_pk_fma_f32 v[178:179], v[176:177], v[204:205], v[178:179] op_sel:[1,1,0] op_sel_hi:[0,1,1] neg_lo:[1,0,0]
    v_cvt_pk_bf16_f32 v52, v164, v166
    v_cvt_pk_bf16_f32 v53, v168, v170
    v_cvt_pk_bf16_f32 v54, v172, v174
    v_cvt_pk_bf16_f32 v55, v176, v178
    ds_write_b128 v5, v[52:55] offset:36864
    ds_read_b64_tr_b16 v[52:53], v244 offset:36864
    ds_read_b64_tr_b16 v[54:55], v245 offset:36864
    v_cvt_pk_bf16_f32 v56, -v165, -v167
    v_cvt_pk_bf16_f32 v57, -v169, -v171
    v_cvt_pk_bf16_f32 v58, -v173, -v175
    v_cvt_pk_bf16_f32 v59, -v177, -v179
    ds_write_b128 v5, v[56:59] offset:37888
    ds_read_b64_tr_b16 v[56:57], v244 offset:37888
    ds_read_b64_tr_b16 v[58:59], v245 offset:37888
    s_waitcnt lgkmcnt(3)
    buffer_store_dwordx4 v[52:55], v243, s[32:35], s30 offen offset:2048 sc1
    s_waitcnt lgkmcnt(0)
    buffer_store_dwordx4 v[56:59], v243, s[32:35], s31 offen offset:2048 sc1
    v_mov_b32 v90, 0
    v_mov_b32_e64 v91, 0
    s_waitcnt vmcnt(15)
    v_dot2_f32_bf16 v90, v70, v80, v90
    v_dot2_f32_bf16 v91, v71, v81, v91
    v_dot2_f32_bf16 v90, v72, v82, v90
    v_dot2_f32_bf16 v91, v73, v83, v91
    v_dot2_f32_bf16 v90, v74, v84, v90
    v_dot2_f32_bf16 v91, v75, v85, v91
    v_dot2_f32_bf16 v90, v76, v86, v90
    v_dot2_f32_bf16 v91, v77, v87, v91
    v_dot2_f32_bf16 v90, v78, v88, v90
    v_dot2_f32_bf16 v91, v79, v89, v91
    v_mov_b32 v253, s10
    v_mov_b32 v255, s10
    s_nop 0
    v_add_f32_e64 v90, v90, v91
    s_nop 1
    v_add_f32_dpp v90, v90, v90 row_ror:8 row_mask:0xf bank_mask:0xf
    s_nop 1
    v_add_f32_dpp v90, v90, v90 row_ror:4 row_mask:0xf bank_mask:0xf
    s_nop 1
    v_add_f32_dpp v90, v90, v90 row_ror:2 row_mask:0xf bank_mask:0xf
    s_nop 1
    v_add_f32_dpp v90, v90, v90 row_ror:1 row_mask:0xf bank_mask:0xf
    v_mov_b32 v91, v90
    s_nop 1
    v_permlane16_swap_b32 v90, v91
    v_add_f32_e64 v90, v90, v91
    v_cvt_pk_bf16_f32 v90, v90, v90
    v_lshlrev_b32_e64 v90, 16, v90
    v_mul_f32 v90, 0xbfb8aa3b, v90
    v_exp_f32 v90, v90
    s_nop 0
    v_add_f32 v90, 1.0, v90
    v_rcp_f32_e64 v90, v90
    s_nop 0
    v_cvt_pk_bf16_f32 v90, v90, v90
    v_lshlrev_b32 v252, 16, v90
    v_mov_b32 v254, v252
    s_nop 1
    v_permlane32_swap_b32 v252, v254
    v_and_b32 v14, 63, v0
    v_lshlrev_b32 v216, 4, v14
    v_lshrrev_b32 v15, 3, v14
    s_lshl_b32 s12, s6, 10
    v_lshl_add_u32 v8, v15, 7, s12
    v_and_b32 v15, 3, v0
    v_lshlrev_b32 v2, 3, v15
    v_add_u32 v2, 163456, v2
    v_lshrrev_b32_e64 v16, 2, v14
    v_lshl_add_u32 v16, v15, 4, v16
    v_lshlrev_b32 v215, 2, v16
    v_and_b32 v15, 15, v0
    v_lshrrev_b32_e64 v16, 4, v14
    v_lshl_add_u32 v16, v15, 2, v16
    v_lshlrev_b32 v214, 2, v16
    v_lshrrev_b32 v15, 1, v15
    v_lshlrev_b32 v9, 5, v15
    v_lshlrev_b32 v3, 1, v231
    s_mul_i32 s12, s8, 10240
    s_add_u32 s12, s12, 32768
    v_add_u32_e64 v213, s12, v216
    s_add_u32 s12, s8, 1
    s_and_b32 s12, s12, 3
    s_mul_i32 s12, s12, 10240
    s_add_u32 s12, s12, 32768
    v_add_u32_e64 v212, s12, v216
    s_mul_i32 s28, s86, 5120
    s_add_u32 s28, s28, 11141120
    s_mul_i32 s29, s87, 5120
    s_add_u32 s29, s29, 11141120
    s_add_u32 s30, s28, 4096
    s_add_u32 s31, s29, 4096
    s_lshl_b32 s86, s86, 7
    s_add_u32 s86, s86, 135168
    s_lshl_b32 s87, s87, 7
    s_add_u32 s87, s87, 135168
    ds_read_b64 v[100:101], v2 offset:0
    ds_read_b64 v[110:111], v2 offset:160
    ds_read_b64 v[102:103], v2 offset:32
    ds_read_b64 v[112:113], v2 offset:192
    ds_read_b64 v[104:105], v2 offset:64
    ds_read_b64 v[114:115], v2 offset:224
    ds_read_b64 v[106:107], v2 offset:96
    ds_read_b64 v[116:117], v2 offset:256
    ds_read_b64 v[108:109], v2 offset:128
    ds_read_b64 v[118:119], v2 offset:288
    s_waitcnt vmcnt(10) lgkmcnt(0)
    v_lshlrev_b32 v130, 16, v190
    v_and_b32 v131, 0xffff0000, v190
    v_lshlrev_b32_e64 v132, 16, v191
    v_and_b32 v133, 0xffff0000, v191
    v_lshlrev_b32_e64 v134, 16, v100
    v_and_b32 v135, 0xffff0000, v100
    v_lshlrev_b32_e64 v136, 16, v101
    v_and_b32 v137, 0xffff0000, v101
    v_pk_mul_f32 v[134:135], v[130:131], v[134:135]
    v_pk_mul_f32 v[136:137], v[132:133], v[136:137]
    v_cvt_pk_bf16_f32 v138, v134, v135
    v_cvt_pk_bf16_f32 v139, v136, v137
    v_lshlrev_b32_e64 v134, 16, v110
    v_and_b32 v135, 0xffff0000, v110
    v_lshlrev_b32_e64 v136, 16, v111
    v_and_b32 v137, 0xffff0000, v111
    v_pk_mul_f32 v[134:135], v[130:131], v[134:135]
    v_pk_mul_f32 v[136:137], v[132:133], v[136:137]
    v_cvt_pk_bf16_f32 v140, v134, v135
    v_cvt_pk_bf16_f32 v141, v136, v137
    ds_bpermute_b32 v222, v214, v138
    ds_bpermute_b32 v223, v214, v139
    ds_bpermute_b32 v224, v214, v140
    ds_bpermute_b32 v225, v214, v141
    v_lshlrev_b32_e64 v130, 16, v192
    v_and_b32 v131, 0xffff0000, v192
    v_lshlrev_b32_e64 v132, 16, v193
    v_and_b32 v133, 0xffff0000, v193
    v_lshlrev_b32_e64 v134, 16, v102
    v_and_b32 v135, 0xffff0000, v102
    v_lshlrev_b32_e64 v136, 16, v103
    v_and_b32 v137, 0xffff0000, v103
    v_pk_mul_f32 v[134:135], v[130:131], v[134:135]
    v_pk_mul_f32 v[136:137], v[132:133], v[136:137]
    v_cvt_pk_bf16_f32 v142, v134, v135
    v_cvt_pk_bf16_f32 v143, v136, v137
    v_lshlrev_b32_e64 v134, 16, v112
    v_and_b32 v135, 0xffff0000, v112
    v_lshlrev_b32_e64 v136, 16, v113
    v_and_b32 v137, 0xffff0000, v113
    v_pk_mul_f32 v[134:135], v[130:131], v[134:135]
    v_pk_mul_f32 v[136:137], v[132:133], v[136:137]
    v_cvt_pk_bf16_f32 v144, v134, v135
    v_cvt_pk_bf16_f32 v145, v136, v137
    ds_bpermute_b32 v226, v214, v142
    ds_bpermute_b32 v227, v214, v143
    ds_bpermute_b32 v228, v214, v144
    ds_bpermute_b32 v229, v214, v145
    v_lshlrev_b32_e64 v130, 16, v194
    v_and_b32 v131, 0xffff0000, v194
    v_lshlrev_b32_e64 v132, 16, v195
    v_and_b32 v133, 0xffff0000, v195
    v_lshlrev_b32_e64 v134, 16, v104
    v_and_b32 v135, 0xffff0000, v104
    v_lshlrev_b32_e64 v136, 16, v105
    v_and_b32 v137, 0xffff0000, v105
    v_pk_mul_f32 v[134:135], v[130:131], v[134:135]
    v_pk_mul_f32 v[136:137], v[132:133], v[136:137]
    v_cvt_pk_bf16_f32 v138, v134, v135
    v_cvt_pk_bf16_f32 v139, v136, v137
    v_lshlrev_b32_e64 v134, 16, v114
    v_and_b32 v135, 0xffff0000, v114
    v_lshlrev_b32_e64 v136, 16, v115
    v_and_b32 v137, 0xffff0000, v115
    v_pk_mul_f32 v[134:135], v[130:131], v[134:135]
    v_pk_mul_f32 v[136:137], v[132:133], v[136:137]
    v_cvt_pk_bf16_f32 v140, v134, v135
    v_cvt_pk_bf16_f32 v141, v136, v137
    ds_bpermute_b32 v230, v214, v138
    ds_bpermute_b32 v231, v214, v139
    ds_bpermute_b32 v232, v214, v140
    ds_bpermute_b32 v233, v214, v141
    v_lshlrev_b32_e64 v130, 16, v92
    v_and_b32 v131, 0xffff0000, v92
    v_lshlrev_b32_e64 v132, 16, v93
    v_and_b32 v133, 0xffff0000, v93
    v_lshlrev_b32_e64 v134, 16, v106
    v_and_b32 v135, 0xffff0000, v106
    v_lshlrev_b32_e64 v136, 16, v107
    v_and_b32 v137, 0xffff0000, v107
    v_pk_mul_f32 v[134:135], v[130:131], v[134:135]
    v_pk_mul_f32 v[136:137], v[132:133], v[136:137]
    v_cvt_pk_bf16_f32 v142, v134, v135
    v_cvt_pk_bf16_f32 v143, v136, v137
    v_lshlrev_b32_e64 v134, 16, v116
    v_and_b32 v135, 0xffff0000, v116
    v_lshlrev_b32_e64 v136, 16, v117
    v_and_b32 v137, 0xffff0000, v117
    v_pk_mul_f32 v[134:135], v[130:131], v[134:135]
    v_pk_mul_f32 v[136:137], v[132:133], v[136:137]
    v_cvt_pk_bf16_f32 v144, v134, v135
    v_cvt_pk_bf16_f32 v145, v136, v137
    ds_bpermute_b32 v234, v214, v142
    ds_bpermute_b32 v235, v214, v143
    ds_bpermute_b32 v236, v214, v144
    ds_bpermute_b32 v237, v214, v145
    v_lshlrev_b32_e64 v130, 16, v94
    v_and_b32 v131, 0xffff0000, v94
    v_lshlrev_b32_e64 v132, 16, v95
    v_and_b32 v133, 0xffff0000, v95
    v_lshlrev_b32_e64 v134, 16, v108
    v_and_b32 v135, 0xffff0000, v108
    v_lshlrev_b32_e64 v136, 16, v109
    v_and_b32 v137, 0xffff0000, v109
    v_pk_mul_f32 v[134:135], v[130:131], v[134:135]
    v_pk_mul_f32 v[136:137], v[132:133], v[136:137]
    v_cvt_pk_bf16_f32 v138, v134, v135
    v_cvt_pk_bf16_f32 v139, v136, v137
    v_lshlrev_b32_e64 v134, 16, v118
    v_and_b32 v135, 0xffff0000, v118
    v_lshlrev_b32_e64 v136, 16, v119
    v_and_b32 v137, 0xffff0000, v119
    v_pk_mul_f32 v[134:135], v[130:131], v[134:135]
    v_pk_mul_f32 v[136:137], v[132:133], v[136:137]
    v_cvt_pk_bf16_f32 v140, v134, v135
    v_cvt_pk_bf16_f32 v141, v136, v137
    ds_bpermute_b32 v238, v214, v138
    ds_bpermute_b32 v239, v214, v139
    ds_bpermute_b32 v240, v214, v140
    ds_bpermute_b32 v241, v214, v141
    s_waitcnt vmcnt(0) lgkmcnt(0)
    s_mov_b64 exec, 0xff
    buffer_store_dwordx4 v[252:255], v216, s[32:35], s82 offen sc1
    s_mov_b64 exec, -1
    s_add_u32 m0, s9, 73728
    s_add_u32 s11, s63, 20480
    buffer_load_dwordx4 v18, s[24:27], s11 offen lds
    buffer_load_dwordx4 v19, s[24:27], s11 offen offset:1024 lds
    s_add_u32 m0, s9, 75776
    s_add_u32 s11, s63, 40960
    buffer_load_dwordx4 v18, s[24:27], s11 offen lds
    buffer_load_dwordx4 v19, s[24:27], s11 offen offset:1024 lds
    s_add_u32 m0, s9, 77824
    s_add_u32 s11, s63, 61440
    buffer_load_dwordx4 v18, s[24:27], s11 offen lds
    buffer_load_dwordx4 v19, s[24:27], s11 offen offset:1024 lds
    s_add_u32 m0, s9, 79872
    s_add_u32 s11, s63, 81920
    buffer_load_dwordx4 v18, s[24:27], s11 offen lds
    buffer_load_dwordx4 v19, s[24:27], s11 offen offset:1024 lds
    s_add_u32 m0, s9, 110592
    s_add_u32 s11, s64, 0
    buffer_load_dwordx4 v18, s[24:27], s11 offen lds
    buffer_load_dwordx4 v19, s[24:27], s11 offen offset:1024 lds
    s_add_u32 m0, s9, 112640
    s_add_u32 s11, s64, 20480
    buffer_load_dwordx4 v18, s[24:27], s11 offen lds
    buffer_load_dwordx4 v19, s[24:27], s11 offen offset:1024 lds
    s_add_u32 m0, s9, 114688
    s_add_u32 s11, s64, 40960
    buffer_load_dwordx4 v18, s[24:27], s11 offen lds
    buffer_load_dwordx4 v19, s[24:27], s11 offen offset:1024 lds
    s_add_u32 m0, s9, 116736
    s_add_u32 s11, s64, 61440
    buffer_load_dwordx4 v18, s[24:27], s11 offen lds
    buffer_load_dwordx4 v19, s[24:27], s11 offen offset:1024 lds
    s_add_u32 m0, s9, 0
    s_add_u32 s11, s64, 81920
    buffer_load_dwordx4 v18, s[24:27], s11 offen lds
    buffer_load_dwordx4 v19, s[24:27], s11 offen offset:1024 lds
    s_mov_b32 s3, 20000
    s_waitcnt vmcnt(0)
    buffer_load_dwordx4 v[242:245], v8, s[32:35], s83 offen sc1
    ds_read_b128 a[128:131], v12 offset:0
    ds_read_b128 a[132:135], v13 offset:0
    ds_read_b128 a[136:139], v12 offset:2048
    ds_read_b128 a[140:143], v13 offset:2048
    ds_read_b128 a[144:147], v12 offset:4096
    ds_read_b128 a[148:151], v13 offset:4096
    ds_read_b128 a[152:155], v12 offset:6144
    ds_read_b128 a[156:159], v13 offset:6144
    ds_read_b128 a[160:163], v12 offset:36864
    ds_read_b128 a[164:167], v13 offset:36864
    ds_read_b128 a[168:171], v12 offset:38912
    ds_read_b128 a[172:175], v13 offset:38912
    ds_read_b128 a[176:179], v12 offset:40960
    ds_read_b128 a[180:183], v13 offset:40960
    ds_read_b128 a[184:187], v12 offset:43008
    ds_read_b128 a[188:191], v13 offset:43008
    ds_read_b128 a[192:195], v10 offset:0
    ds_read_b128 a[196:199], v11 offset:0
    s_waitcnt vmcnt(0)
    v_cmp_ne_u32_e64 vcc, s10, v243
    v_cmp_ne_u32 s[14:15], s10, v245
    s_or_b64 vcc, vcc, s[14:15]
    s_cbranch_vccz L_got2
L_poll2:
    buffer_load_dwordx4 v[242:245], v8, s[32:35], s83 offen sc1
    s_sub_u32 s3, s3, 1
    s_waitcnt vmcnt(0)
    v_cmp_ne_u32_e64 vcc, s10, v243
    v_cmp_ne_u32 s[14:15], s10, v245
    s_or_b64 vcc, vcc, s[14:15]
    s_cmp_eq_u32 s3, 0
    s_cbranch_scc1 L_got2
    s_cbranch_vccnz L_poll2
L_got2:
    s_barrier
    s_sub_u32 s12, s65, 0
    s_and_b32 s12, s12, 3
    s_mul_i32 s12, s12, 10240
    s_add_u32 s66, s12, s84
    s_lshl4_add_u32 s11, s60, s66
    buffer_load_dwordx4 v[20:23], v216, s[32:35], s11 offen offset:0 sc1
    buffer_load_dwordx4 v[24:27], v216, s[32:35], s11 offen offset:1024 sc1
    s_lshl4_add_u32 s11, s61, s66
    buffer_load_dwordx4 v[28:31], v216, s[32:35], s11 offen offset:0 sc1
    buffer_load_dwordx4 v[32:35], v216, s[32:35], s11 offen offset:1024 sc1
    s_lshl4_add_u32 s11, s62, s66
    buffer_load_dwordx4 v[36:39], v216, s[32:35], s11 offen offset:0 sc1
    buffer_load_dwordx4 v[40:43], v216, s[32:35], s11 offen offset:1024 sc1
    s_lshl4_add_u32 s11, s63, s66
    buffer_load_dwordx4 v[44:47], v216, s[32:35], s11 offen offset:0 sc1
    buffer_load_dwordx4 v[48:51], v216, s[32:35], s11 offen offset:1024 sc1
    s_lshl4_add_u32 s11, s64, s66
    buffer_load_dwordx4 v[52:55], v216, s[32:35], s11 offen offset:0 sc1
    buffer_load_dwordx4 v[56:59], v216, s[32:35], s11 offen offset:1024 sc1
    s_sub_u32 s12, s65, 1
    s_and_b32 s12, s12, 3
    s_mul_i32 s12, s12, 10240
    s_add_u32 s66, s12, s84
    s_lshl4_add_u32 s11, s60, s66
    buffer_load_dwordx4 v[60:63], v216, s[32:35], s11 offen offset:0 sc1
    buffer_load_dwordx4 v[64:67], v216, s[32:35], s11 offen offset:1024 sc1
    ds_bpermute_b32 v246, v9, v242
    ds_bpermute_b32 v247, v9, v244
    s_mov_b32 s3, 20000
    v_and_b32 v248, 1, v0
    v_cmp_ne_u32 vcc, 0, v248
    s_waitcnt lgkmcnt(0)
    s_nop 0
    v_cndmask_b32 v218, v246, v247, vcc
    v_sub_f32_e64 v219, 1.0, v218
    v_cvt_pk_bf16_f32 v219, v219, v219
    v_lshlrev_b32 v219, 16, v219
    s_cmp_eq_u32 s7, 1
    s_cselect_b64 vcc, -1, 0
    v_cndmask_b32 v220, v218, v219, vcc
    v_cndmask_b32 v221, v219, v218, vcc
    v_mov_b32 v248, s10
    v_mov_b32 v249, 0
    v_lshlrev_b32 v200, 16, v222
    v_and_b32 v201, 0xffff0000, v222
    v_lshlrev_b32_e64 v202, 16, v223
    v_and_b32 v203, 0xffff0000, v223
    v_mul_f32 v180, v218, v200
    v_mul_f32 v181, v218, v201
    v_mul_f32 v182, v218, v202
    v_mul_f32 v183, v218, v203
    v_lshlrev_b32_e64 v200, 16, v224
    v_and_b32 v201, 0xffff0000, v224
    v_lshlrev_b32_e64 v202, 16, v225
    v_and_b32 v203, 0xffff0000, v225
    v_fmac_f32 v180, v219, v200
    v_fmac_f32 v181, v219, v201
    v_fmac_f32 v182, v219, v202
    v_fmac_f32 v183, v219, v203
    v_lshlrev_b32_e64 v200, 16, v226
    v_and_b32 v201, 0xffff0000, v226
    v_lshlrev_b32_e64 v202, 16, v227
    v_and_b32 v203, 0xffff0000, v227
    v_mul_f32 v184, v218, v200
    v_mul_f32 v185, v218, v201
    v_mul_f32 v186, v218, v202
    v_mul_f32 v187, v218, v203
    v_lshlrev_b32_e64 v200, 16, v228
    v_and_b32 v201, 0xffff0000, v228
    v_lshlrev_b32_e64 v202, 16, v229
    v_and_b32 v203, 0xffff0000, v229
    v_fmac_f32 v184, v219, v200
    v_fmac_f32 v185, v219, v201
    v_fmac_f32 v186, v219, v202
    v_fmac_f32_e64 v187, v219, v203
    s_waitcnt vmcnt(11) lgkmcnt(0)
    v_mfma_f32_16x16x32_bf16 v[140:143], a[0:3], v[20:23], 0
    s_waitcnt vmcnt(10)
    v_mfma_f32_16x16x32_bf16 v[140:143], a[4:7], v[24:27], v[140:143]
    s_lshl4_add_u32 s11, s61, s66
    s_waitcnt vmcnt(9)
    v_mfma_f32_16x16x32_bf16 v[140:143], a[40:43], v[28:31], v[140:143]
    buffer_load_dwordx4 v[68:71], v216, s[32:35], s11 offen offset:0 sc1
    s_waitcnt vmcnt(9)
    v_mfma_f32_16x16x32_bf16 v[140:143], a[44:47], v[32:35], v[140:143]
    s_waitcnt vmcnt(8)
    v_mfma_f32_16x16x32_bf16 v[140:143], a[80:83], v[36:39], v[140:143]
    buffer_load_dwordx4 v[72:75], v216, s[32:35], s11 offen offset:1024 sc1
    s_waitcnt vmcnt(8)
    v_mfma_f32_16x16x32_bf16 v[140:143], a[84:87], v[40:43], v[140:143]
    s_waitcnt vmcnt(7)
    v_mfma_f32_16x16x32_bf16 v[140:143], a[120:123], v[44:47], v[140:143]
    s_lshl4_add_u32 s11, s62, s66
    s_waitcnt vmcnt(6)
    v_mfma_f32_16x16x32_bf16 v[140:143], a[124:127], v[48:51], v[140:143]
    s_waitcnt vmcnt(5)
    v_mfma_f32_16x16x32_bf16 v[140:143], a[160:163], v[52:55], v[140:143]
    buffer_load_dwordx4 v[76:79], v216, s[32:35], s11 offen offset:0 sc1
    s_waitcnt vmcnt(5)
    v_mfma_f32_16x16x32_bf16 v[140:143], a[164:167], v[56:59], v[140:143]
    v_mfma_f32_16x16x32_bf16 v[144:147], a[8:11], v[20:23], 0
    v_mfma_f32_16x16x32_bf16 v[144:147], a[12:15], v[24:27], v[144:147]
    buffer_load_dwordx4 v[80:83], v216, s[32:35], s11 offen offset:1024 sc1
    v_mfma_f32_16x16x32_bf16 v[144:147], a[48:51], v[28:31], v[144:147]
    v_mfma_f32_16x16x32_bf16 v[144:147], a[52:55], v[32:35], v[144:147]
    s_lshl4_add_u32 s11, s63, s66
    v_mfma_f32_16x16x32_bf16 v[144:147], a[88:91], v[36:39], v[144:147]
    v_mfma_f32_16x16x32_bf16 v[144:147], a[92:95], v[40:43], v[144:147]
    ds_write_b128 v212, v[140:143] offset:0
    buffer_load_dwordx4 v[84:87], v216, s[32:35], s11 offen offset:0 sc1
    v_mfma_f32_16x16x32_bf16 v[144:147], a[128:131], v[44:47], v[144:147]
    v_mfma_f32_16x16x32_bf16 v[144:147], a[132:135], v[48:51], v[144:147]
    buffer_load_dwordx4 v[88:91], v216, s[32:35], s11 offen offset:1024 sc1
    v_mfma_f32_16x16x32_bf16 v[144:147], a[168:171], v[52:55], v[144:147]
    v_mfma_f32_16x16x32_bf16 v[144:147], a[172:175], v[56:59], v[144:147]
    v_mfma_f32_16x16x32_bf16 v[148:151], a[16:19], v[20:23], 0
    v_mfma_f32_16x16x32_bf16 v[148:151], a[20:23], v[24:27], v[148:151]
    s_lshl4_add_u32 s11, s64, s66
    v_mfma_f32_16x16x32_bf16 v[148:151], a[56:59], v[28:31], v[148:151]
    buffer_load_dwordx4 v[92:95], v216, s[32:35], s11 offen offset:0 sc1
    v_mfma_f32_16x16x32_bf16 v[148:151], a[60:63], v[32:35], v[148:151]
    buffer_load_dwordx4 v[96:99], v216, s[32:35], s11 offen offset:1024 sc1
    v_mfma_f32_16x16x32_bf16 v[148:151], a[96:99], v[36:39], v[148:151]
    s_sub_u32 s12, s65, 2
    v_mfma_f32_16x16x32_bf16 v[148:151], a[100:103], v[40:43], v[148:151]
    ds_write_b128 v212, v[144:147] offset:1024
    s_and_b32 s12, s12, 3
    v_mfma_f32_16x16x32_bf16 v[148:151], a[136:139], v[44:47], v[148:151]
    s_mul_i32 s12, s12, 10240
    v_mfma_f32_16x16x32_bf16 v[148:151], a[140:143], v[48:51], v[148:151]
    s_add_u32 s66, s12, s84
    v_mfma_f32_16x16x32_bf16 v[148:151], a[176:179], v[52:55], v[148:151]
    s_lshl4_add_u32 s11, s60, s66
    v_mfma_f32_16x16x32_bf16 v[148:151], a[180:183], v[56:59], v[148:151]
    buffer_load_dwordx4 v[100:103], v216, s[32:35], s11 offen offset:0 sc1
    v_mfma_f32_16x16x32_bf16 v[152:155], a[24:27], v[20:23], 0
    v_mfma_f32_16x16x32_bf16 v[152:155], a[28:31], v[24:27], v[152:155]
    buffer_load_dwordx4 v[104:107], v216, s[32:35], s11 offen offset:1024 sc1
    v_mfma_f32_16x16x32_bf16 v[152:155], a[64:67], v[28:31], v[152:155]
    v_mfma_f32_16x16x32_bf16 v[152:155], a[68:71], v[32:35], v[152:155]
    s_lshl4_add_u32 s11, s61, s66
    v_mfma_f32_16x16x32_bf16 v[152:155], a[104:107], v[36:39], v[152:155]
    v_mfma_f32_16x16x32_bf16 v[152:155], a[108:111], v[40:43], v[152:155]
    ds_write_b128 v212, v[148:151] offset:2048
    buffer_load_dwordx4 v[108:111], v216, s[32:35], s11 offen offset:0 sc1
    v_mfma_f32_16x16x32_bf16 v[152:155], a[144:147], v[44:47], v[152:155]
    v_mfma_f32_16x16x32_bf16 v[152:155], a[148:151], v[48:51], v[152:155]
    buffer_load_dwordx4 v[112:115], v216, s[32:35], s11 offen offset:1024 sc1
    v_mfma_f32_16x16x32_bf16 v[152:155], a[184:187], v[52:55], v[152:155]
    v_mfma_f32_16x16x32_bf16 v[152:155], a[188:191], v[56:59], v[152:155]
    s_waitcnt lgkmcnt(1)
    s_barrier
    v_mfma_f32_16x16x32_bf16 v[156:159], a[32:35], v[20:23], 0
    ds_read_b128 v[140:143], v213 offset:0
    v_mfma_f32_16x16x32_bf16 v[156:159], a[36:39], v[24:27], v[156:159]
    s_lshl4_add_u32 s11, s62, s66
    v_mfma_f32_16x16x32_bf16 v[156:159], a[72:75], v[28:31], v[156:159]
    buffer_load_dwordx4 v[116:119], v216, s[32:35], s11 offen offset:0 sc1
    v_mfma_f32_16x16x32_bf16 v[156:159], a[76:79], v[32:35], v[156:159]
    v_mfma_f32_16x16x32_bf16 v[156:159], a[112:115], v[36:39], v[156:159]
    buffer_load_dwordx4 v[120:123], v216, s[32:35], s11 offen offset:1024 sc1
    v_mfma_f32_16x16x32_bf16 v[156:159], a[116:119], v[40:43], v[156:159]
    ds_write_b128 v212, v[152:155] offset:3072
    v_mfma_f32_16x16x32_bf16 v[156:159], a[152:155], v[44:47], v[156:159]
    s_lshl4_add_u32 s11, s63, s66
    v_mfma_f32_16x16x32_bf16 v[156:159], a[156:159], v[48:51], v[156:159]
    v_mfma_f32_16x16x32_bf16 v[156:159], a[192:195], v[52:55], v[156:159]
    buffer_load_dwordx4 v[124:127], v216, s[32:35], s11 offen offset:0 sc1
    v_mfma_f32_16x16x32_bf16 v[156:159], a[196:199], v[56:59], v[156:159]
    s_waitcnt vmcnt(12)
    s_waitcnt lgkmcnt(1)
    v_mfma_f32_16x16x32_bf16 v[140:143], a[0:3], v[60:63], v[140:143]
    ds_read_b128 v[144:147], v213 offset:1024
    v_lshlrev_b32_e64 v200, 16, v230
    v_mfma_f32_16x16x32_bf16 v[140:143], a[4:7], v[64:67], v[140:143]
    buffer_load_dwordx4 v[128:131], v216, s[32:35], s11 offen offset:1024 sc1
    v_mfma_f32_16x16x32_bf16 v[140:143], a[40:43], v[68:71], v[140:143]
    v_and_b32 v201, 0xffff0000, v230
    v_mfma_f32_16x16x32_bf16 v[140:143], a[44:47], v[72:75], v[140:143]
    s_lshl4_add_u32 s11, s64, s66
    v_mfma_f32_16x16x32_bf16 v[140:143], a[80:83], v[76:79], v[140:143]
    v_lshlrev_b32_e64 v202, 16, v231
    s_waitcnt vmcnt(8)
    v_mfma_f32_16x16x32_bf16 v[140:143], a[84:87], v[80:83], v[140:143]
    ds_write_b128 v212, v[156:159] offset:4096
    buffer_load_dwordx4 v[132:135], v216, s[32:35], s11 offen offset:0 sc1
    v_mfma_f32_16x16x32_bf16 v[140:143], a[120:123], v[84:87], v[140:143]
    v_and_b32 v203, 0xffff0000, v231
    v_mfma_f32_16x16x32_bf16 v[140:143], a[124:127], v[88:91], v[140:143]
    buffer_load_dwordx4 v[136:139], v216, s[32:35], s11 offen offset:1024 sc1
    v_mfma_f32_16x16x32_bf16 v[140:143], a[160:163], v[92:95], v[140:143]
    v_mul_f32_e64 v188, v218, v200
    v_mfma_f32_16x16x32_bf16 v[140:143], a[164:167], v[96:99], v[140:143]
    s_waitcnt lgkmcnt(1)
    s_barrier
    v_mfma_f32_16x16x32_bf16 v[144:147], a[8:11], v[60:63], v[144:147]
    ds_read_b128 v[148:151], v213 offset:2048
    v_mul_f32_e64 v189, v218, v201
    v_mfma_f32_16x16x32_bf16 v[144:147], a[12:15], v[64:67], v[144:147]
    s_sub_u32 s12, s65, 3
    v_mfma_f32_16x16x32_bf16 v[144:147], a[48:51], v[68:71], v[144:147]
    s_and_b32 s12, s12, 3
    v_mul_f32_e64 v190, v218, v202
    v_mfma_f32_16x16x32_bf16 v[144:147], a[52:55], v[72:75], v[144:147]
    s_mul_i32 s12, s12, 10240
    v_mfma_f32_16x16x32_bf16 v[144:147], a[88:91], v[76:79], v[144:147]
    s_add_u32 s66, s12, s84
    v_mul_f32 v191, v218, v203
    v_mfma_f32_16x16x32_bf16 v[144:147], a[92:95], v[80:83], v[144:147]
    ds_write_b128 v212, v[140:143] offset:5120
    s_lshl4_add_u32 s11, s60, s66
    v_mfma_f32_16x16x32_bf16 v[144:147], a[128:131], v[84:87], v[144:147]
    buffer_load_dwordx4 v[20:23], v216, s[32:35], s11 offen offset:0 sc1
    v_lshlrev_b32 v200, 16, v232
    v_mfma_f32_16x16x32_bf16 v[144:147], a[132:135], v[88:91], v[144:147]
    buffer_load_dwordx4 v[24:27], v216, s[32:35], s11 offen offset:1024 sc1
    v_mfma_f32_16x16x32_bf16 v[144:147], a[168:171], v[92:95], v[144:147]
    s_lshl4_add_u32 s11, s61, s66
    v_and_b32 v201, 0xffff0000, v232
    v_mfma_f32_16x16x32_bf16 v[144:147], a[172:175], v[96:99], v[144:147]
    buffer_load_dwordx4 v[28:31], v216, s[32:35], s11 offen offset:0 sc1
    s_waitcnt lgkmcnt(1)
    v_mfma_f32_16x16x32_bf16 v[148:151], a[16:19], v[60:63], v[148:151]
    ds_read_b128 v[152:155], v213 offset:3072
    v_lshlrev_b32_e64 v202, 16, v233
    v_mfma_f32_16x16x32_bf16 v[148:151], a[20:23], v[64:67], v[148:151]
    buffer_load_dwordx4 v[32:35], v216, s[32:35], s11 offen offset:1024 sc1
    v_mfma_f32_16x16x32_bf16 v[148:151], a[56:59], v[68:71], v[148:151]
    v_and_b32 v203, 0xffff0000, v233
    v_mfma_f32_16x16x32_bf16 v[148:151], a[60:63], v[72:75], v[148:151]
    s_lshl4_add_u32 s11, s62, s66
    v_mfma_f32_16x16x32_bf16 v[148:151], a[96:99], v[76:79], v[148:151]
    v_fmac_f32 v188, v219, v200
    v_mfma_f32_16x16x32_bf16 v[148:151], a[100:103], v[80:83], v[148:151]
    ds_write_b128 v212, v[144:147] offset:6144
    buffer_load_dwordx4 v[36:39], v216, s[32:35], s11 offen offset:0 sc1
    v_mfma_f32_16x16x32_bf16 v[148:151], a[136:139], v[84:87], v[148:151]
    v_fmac_f32_e64 v189, v219, v201
    v_mfma_f32_16x16x32_bf16 v[148:151], a[140:143], v[88:91], v[148:151]
    buffer_load_dwordx4 v[40:43], v216, s[32:35], s11 offen offset:1024 sc1
    v_mfma_f32_16x16x32_bf16 v[148:151], a[176:179], v[92:95], v[148:151]
    v_fmac_f32_e64 v190, v219, v202
    v_mfma_f32_16x16x32_bf16 v[148:151], a[180:183], v[96:99], v[148:151]
    s_waitcnt lgkmcnt(1)
    s_barrier
    v_mfma_f32_16x16x32_bf16 v[152:155], a[24:27], v[60:63], v[152:155]
    ds_read_b128 v[156:159], v213 offset:4096
    v_fmac_f32_e64 v191, v219, v203
    v_mfma_f32_16x16x32_bf16 v[152:155], a[28:31], v[64:67], v[152:155]
    s_lshl4_add_u32 s11, s63, s66
    v_mfma_f32_16x16x32_bf16 v[152:155], a[64:67], v[68:71], v[152:155]
    buffer_load_dwordx4 v[44:47], v216, s[32:35], s11 offen offset:0 sc1
    v_lshlrev_b32 v200, 16, v234
    v_mfma_f32_16x16x32_bf16 v[152:155], a[68:71], v[72:75], v[152:155]
    v_mfma_f32_16x16x32_bf16 v[152:155], a[104:107], v[76:79], v[152:155]
    buffer_load_dwordx4 v[48:51], v216, s[32:35], s11 offen offset:1024 sc1
    v_and_b32 v201, 0xffff0000, v234
    v_mfma_f32_16x16x32_bf16 v[152:155], a[108:111], v[80:83], v[152:155]
    ds_write_b128 v212, v[148:151] offset:7168
    v_mfma_f32_16x16x32_bf16 v[152:155], a[144:147], v[84:87], v[152:155]
    s_lshl4_add_u32 s11, s64, s66
    v_lshlrev_b32 v202, 16, v235
    v_mfma_f32_16x16x32_bf16 v[152:155], a[148:151], v[88:91], v[152:155]
    v_mfma_f32_16x16x32_bf16 v[152:155], a[184:187], v[92:95], v[152:155]
    buffer_load_dwordx4 v[52:55], v216, s[32:35], s11 offen offset:0 sc1
    v_and_b32 v203, 0xffff0000, v235
    v_mfma_f32_16x16x32_bf16 v[152:155], a[188:191], v[96:99], v[152:155]
    s_waitcnt lgkmcnt(1)
    v_mfma_f32_16x16x32_bf16 v[156:159], a[32:35], v[60:63], v[156:159]
    ds_read_b128 v[140:143], v213 offset:5120
    v_mul_f32 v192, v218, v200
    v_mfma_f32_16x16x32_bf16 v[156:159], a[36:39], v[64:67], v[156:159]
    buffer_load_dwordx4 v[56:59], v216, s[32:35], s11 offen offset:1024 sc1
    v_mfma_f32_16x16x32_bf16 v[156:159], a[72:75], v[68:71], v[156:159]
    v_mul_f32_e64 v193, v218, v201
    v_mfma_f32_16x16x32_bf16 v[156:159], a[76:79], v[72:75], v[156:159]
    v_mfma_f32_16x16x32_bf16 v[156:159], a[112:115], v[76:79], v[156:159]
    v_mul_f32_e64 v194, v218, v202
    v_mfma_f32_16x16x32_bf16 v[156:159], a[116:119], v[80:83], v[156:159]
    ds_write_b128 v212, v[152:155] offset:8192
    v_mfma_f32_16x16x32_bf16 v[156:159], a[152:155], v[84:87], v[156:159]
    v_mul_f32_e64 v195, v218, v203
    v_mfma_f32_16x16x32_bf16 v[156:159], a[156:159], v[88:91], v[156:159]
    v_mfma_f32_16x16x32_bf16 v[156:159], a[192:195], v[92:95], v[156:159]
    v_lshlrev_b32_e64 v200, 16, v236
    v_mfma_f32_16x16x32_bf16 v[156:159], a[196:199], v[96:99], v[156:159]
    s_waitcnt vmcnt(15)
    s_waitcnt lgkmcnt(1)
    s_barrier
    v_mfma_f32_16x16x32_bf16 v[140:143], a[0:3], v[100:103], v[140:143]
    ds_read_b128 v[144:147], v213 offset:6144
    v_and_b32 v201, 0xffff0000, v236
    v_mfma_f32_16x16x32_bf16 v[140:143], a[4:7], v[104:107], v[140:143]
    s_sub_u32 s12, s65, 0
    v_mfma_f32_16x16x32_bf16 v[140:143], a[40:43], v[108:111], v[140:143]
    s_and_b32 s12, s12, 3
    v_lshlrev_b32 v202, 16, v237
    v_mfma_f32_16x16x32_bf16 v[140:143], a[44:47], v[112:115], v[140:143]
    s_mul_i32 s12, s12, 10240
    v_mfma_f32_16x16x32_bf16 v[140:143], a[80:83], v[116:119], v[140:143]
    s_add_u32 s66, s12, s85
    v_and_b32 v203, 0xffff0000, v237
    s_waitcnt vmcnt(10)
    v_mfma_f32_16x16x32_bf16 v[140:143], a[84:87], v[120:123], v[140:143]
    ds_write_b128 v212, v[156:159] offset:9216
    v_mfma_f32_16x16x32_bf16 v[140:143], a[120:123], v[124:127], v[140:143]
    s_lshl4_add_u32 s11, s60, s66
    v_fmac_f32 v192, v219, v200
    v_mfma_f32_16x16x32_bf16 v[140:143], a[124:127], v[128:131], v[140:143]
    buffer_load_dwordx4 v[60:63], v216, s[32:35], s11 offen offset:0 sc1
    v_mfma_f32_16x16x32_bf16 v[140:143], a[160:163], v[132:135], v[140:143]
    buffer_load_dwordx4 v[64:67], v216, s[32:35], s11 offen offset:1024 sc1
    v_fmac_f32_e64 v193, v219, v201
    v_mfma_f32_16x16x32_bf16 v[140:143], a[164:167], v[136:139], v[140:143]
    s_waitcnt lgkmcnt(1)
    v_mfma_f32_16x16x32_bf16 v[144:147], a[8:11], v[100:103], v[144:147]
    ds_read_b128 v[148:151], v213 offset:7168
    v_fmac_f32 v194, v219, v202
    v_mfma_f32_16x16x32_bf16 v[144:147], a[12:15], v[104:107], v[144:147]
    s_lshl4_add_u32 s11, s61, s66
    v_mfma_f32_16x16x32_bf16 v[144:147], a[48:51], v[108:111], v[144:147]
    v_fmac_f32 v195, v219, v203
    v_mfma_f32_16x16x32_bf16 v[144:147], a[52:55], v[112:115], v[144:147]
    v_mfma_f32_16x16x32_bf16 v[144:147], a[88:91], v[116:119], v[144:147]
    buffer_load_dwordx4 v[68:71], v216, s[32:35], s11 offen offset:0 sc1
    v_lshlrev_b32_e64 v200, 16, v238
    v_mfma_f32_16x16x32_bf16 v[144:147], a[92:95], v[120:123], v[144:147]
    ds_write_b128 v212, v[140:143] offset:0
    v_mfma_f32_16x16x32_bf16 v[144:147], a[128:131], v[124:127], v[144:147]
    v_and_b32 v201, 0xffff0000, v238
    v_mfma_f32_16x16x32_bf16 v[144:147], a[132:135], v[128:131], v[144:147]
    buffer_load_dwordx4 v[72:75], v216, s[32:35], s11 offen offset:1024 sc1
    v_mfma_f32_16x16x32_bf16 v[144:147], a[168:171], v[132:135], v[144:147]
    v_lshlrev_b32_e64 v202, 16, v239
    v_mfma_f32_16x16x32_bf16 v[144:147], a[172:175], v[136:139], v[144:147]
    s_waitcnt lgkmcnt(1)
    s_barrier
    v_mfma_f32_16x16x32_bf16 v[148:151], a[16:19], v[100:103], v[148:151]
    ds_read_b128 v[152:155], v213 offset:8192
    v_and_b32 v203, 0xffff0000, v239
    v_mfma_f32_16x16x32_bf16 v[148:151], a[20:23], v[104:107], v[148:151]
    s_lshl4_add_u32 s11, s62, s66
    v_mfma_f32_16x16x32_bf16 v[148:151], a[56:59], v[108:111], v[148:151]
    v_mul_f32 v196, v218, v200
    v_mfma_f32_16x16x32_bf16 v[148:151], a[60:63], v[112:115], v[148:151]
    v_mfma_f32_16x16x32_bf16 v[148:151], a[96:99], v[116:119], v[148:151]
    buffer_load_dwordx4 v[76:79], v216, s[32:35], s11 offen offset:0 sc1
    v_mul_f32_e64 v197, v218, v201
    v_mfma_f32_16x16x32_bf16 v[148:151], a[100:103], v[120:123], v[148:151]
    ds_write_b128 v212, v[144:147] offset:1024
    v_mfma_f32_16x16x32_bf16 v[148:151], a[136:139], v[124:127], v[148:151]
    v_mul_f32_e64 v198, v218, v202
    v_mfma_f32_16x16x32_bf16 v[148:151], a[140:143], v[128:131], v[148:151]
    buffer_load_dwordx4 v[80:83], v216, s[32:35], s11 offen offset:1024 sc1
    v_mfma_f32_16x16x32_bf16 v[148:151], a[176:179], v[132:135], v[148:151]
    v_mul_f32_e64 v199, v218, v203
    v_mfma_f32_16x16x32_bf16 v[148:151], a[180:183], v[136:139], v[148:151]
    s_waitcnt lgkmcnt(1)
    v_mfma_f32_16x16x32_bf16 v[152:155], a[24:27], v[100:103], v[152:155]
    ds_read_b128 v[156:159], v213 offset:9216
    v_lshlrev_b32 v200, 16, v240
    v_mfma_f32_16x16x32_bf16 v[152:155], a[28:31], v[104:107], v[152:155]
    s_lshl4_add_u32 s11, s63, s66
    v_mfma_f32_16x16x32_bf16 v[152:155], a[64:67], v[108:111], v[152:155]
    v_and_b32 v201, 0xffff0000, v240
    v_mfma_f32_16x16x32_bf16 v[152:155], a[68:71], v[112:115], v[152:155]
    v_mfma_f32_16x16x32_bf16 v[152:155], a[104:107], v[116:119], v[152:155]
    buffer_load_dwordx4 v[84:87], v216, s[32:35], s11 offen offset:0 sc1
    v_lshlrev_b32 v202, 16, v241
    v_mfma_f32_16x16x32_bf16 v[152:155], a[108:111], v[120:123], v[152:155]
    ds_write_b128 v212, v[148:151] offset:2048
    v_mfma_f32_16x16x32_bf16 v[152:155], a[144:147], v[124:127], v[152:155]
    v_and_b32 v203, 0xffff0000, v241
    v_mfma_f32_16x16x32_bf16 v[152:155], a[148:151], v[128:131], v[152:155]
    buffer_load_dwordx4 v[88:91], v216, s[32:35], s11 offen offset:1024 sc1
    v_mfma_f32_16x16x32_bf16 v[152:155], a[184:187], v[132:135], v[152:155]
    v_fmac_f32_e64 v196, v219, v200
    v_mfma_f32_16x16x32_bf16 v[152:155], a[188:191], v[136:139], v[152:155]
    s_waitcnt lgkmcnt(1)
    s_barrier
    v_mfma_f32_16x16x32_bf16 v[156:159], a[32:35], v[100:103], v[156:159]
    ds_read_b128 v[160:163], v213 offset:0
    v_fmac_f32_e64 v197, v219, v201
    v_mfma_f32_16x16x32_bf16 v[156:159], a[36:39], v[104:107], v[156:159]
    s_lshl4_add_u32 s11, s64, s66
    v_mfma_f32_16x16x32_bf16 v[156:159], a[72:75], v[108:111], v[156:159]
    v_mfma_f32_16x16x32_bf16 v[156:159], a[76:79], v[112:115], v[156:159]
    v_fmac_f32 v198, v219, v202
    v_mfma_f32_16x16x32_bf16 v[156:159], a[112:115], v[116:119], v[156:159]
    buffer_load_dwordx4 v[92:95], v216, s[32:35], s11 offen offset:0 sc1
    v_mfma_f32_16x16x32_bf16 v[156:159], a[116:119], v[120:123], v[156:159]
    ds_write_b128 v212, v[152:155] offset:3072
    v_mfma_f32_16x16x32_bf16 v[156:159], a[152:155], v[124:127], v[156:159]
    v_fmac_f32_e64 v199, v219, v203
    v_mfma_f32_16x16x32_bf16 v[156:159], a[156:159], v[128:131], v[156:159]
    buffer_load_dwordx4 v[96:99], v216, s[32:35], s11 offen offset:1024 sc1
    v_mfma_f32_16x16x32_bf16 v[156:159], a[192:195], v[132:135], v[156:159]
    v_mfma_f32_16x16x32_bf16 v[156:159], a[196:199], v[136:139], v[156:159]
    s_waitcnt vmcnt(15)
    s_waitcnt lgkmcnt(1)
    v_mfma_f32_16x16x32_bf16 v[160:163], a[0:3], v[20:23], v[160:163]
    ds_read_b128 v[164:167], v213 offset:1024
    v_mfma_f32_16x16x32_bf16 v[160:163], a[4:7], v[24:27], v[160:163]
    s_sub_u32 s12, s65, 1
    v_mfma_f32_16x16x32_bf16 v[160:163], a[40:43], v[28:31], v[160:163]
    s_and_b32 s12, s12, 3
    v_mfma_f32_16x16x32_bf16 v[160:163], a[44:47], v[32:35], v[160:163]
    s_mul_i32 s12, s12, 10240
    v_mfma_f32_16x16x32_bf16 v[160:163], a[80:83], v[36:39], v[160:163]
    s_add_u32 s66, s12, s85
    s_waitcnt vmcnt(10)
    v_mfma_f32_16x16x32_bf16 v[160:163], a[84:87], v[40:43], v[160:163]
    ds_write_b128 v212, v[156:159] offset:4096
    v_mfma_f32_16x16x32_bf16 v[160:163], a[120:123], v[44:47], v[160:163]
    s_lshl4_add_u32 s11, s60, s66
    v_mfma_f32_16x16x32_bf16 v[160:163], a[124:127], v[48:51], v[160:163]
    buffer_load_dwordx4 v[100:103], v216, s[32:35], s11 offen offset:0 sc1
    v_mfma_f32_16x16x32_bf16 v[160:163], a[160:163], v[52:55], v[160:163]
    buffer_load_dwordx4 v[104:107], v216, s[32:35], s11 offen offset:1024 sc1
    v_mfma_f32_16x16x32_bf16 v[160:163], a[164:167], v[56:59], v[160:163]
    s_waitcnt lgkmcnt(1)
    s_barrier
    v_mfma_f32_16x16x32_bf16 v[164:167], a[8:11], v[20:23], v[164:167]
    ds_read_b128 v[168:171], v213 offset:2048
    v_mfma_f32_16x16x32_bf16 v[164:167], a[12:15], v[24:27], v[164:167]
    s_lshl4_add_u32 s11, s61, s66
    v_mfma_f32_16x16x32_bf16 v[164:167], a[48:51], v[28:31], v[164:167]
    v_mfma_f32_16x16x32_bf16 v[164:167], a[52:55], v[32:35], v[164:167]
    v_mfma_f32_16x16x32_bf16 v[164:167], a[88:91], v[36:39], v[164:167]
    buffer_load_dwordx4 v[108:111], v216, s[32:35], s11 offen offset:0 sc1
    v_mfma_f32_16x16x32_bf16 v[164:167], a[92:95], v[40:43], v[164:167]
    buffer_store_dwordx4 v[160:163], v216, s[32:35], s28 offen offset:0 sc1
    v_mfma_f32_16x16x32_bf16 v[164:167], a[128:131], v[44:47], v[164:167]
    v_mfma_f32_16x16x32_bf16 v[164:167], a[132:135], v[48:51], v[164:167]
    buffer_load_dwordx4 v[112:115], v216, s[32:35], s11 offen offset:1024 sc1
    v_mfma_f32_16x16x32_bf16 v[164:167], a[168:171], v[52:55], v[164:167]
    v_mfma_f32_16x16x32_bf16 v[164:167], a[172:175], v[56:59], v[164:167]
    s_waitcnt lgkmcnt(0)
    v_mfma_f32_16x16x32_bf16 v[168:171], a[16:19], v[20:23], v[168:171]
    ds_read_b128 v[172:175], v213 offset:3072
    v_mfma_f32_16x16x32_bf16 v[168:171], a[20:23], v[24:27], v[168:171]
    s_lshl4_add_u32 s11, s62, s66
    v_mfma_f32_16x16x32_bf16 v[168:171], a[56:59], v[28:31], v[168:171]
    v_mfma_f32_16x16x32_bf16 v[168:171], a[60:63], v[32:35], v[168:171]
    v_mfma_f32_16x16x32_bf16 v[168:171], a[96:99], v[36:39], v[168:171]
    buffer_load_dwordx4 v[116:119], v216, s[32:35], s11 offen offset:0 sc1
    v_mfma_f32_16x16x32_bf16 v[168:171], a[100:103], v[40:43], v[168:171]
    buffer_store_dwordx4 v[164:167], v216, s[32:35], s28 offen offset:1024 sc1
    v_mfma_f32_16x16x32_bf16 v[168:171], a[136:139], v[44:47], v[168:171]
    v_mfma_f32_16x16x32_bf16 v[168:171], a[140:143], v[48:51], v[168:171]
    buffer_load_dwordx4 v[120:123], v216, s[32:35], s11 offen offset:1024 sc1
    v_mfma_f32_16x16x32_bf16 v[168:171], a[176:179], v[52:55], v[168:171]
    v_mfma_f32_16x16x32_bf16 v[168:171], a[180:183], v[56:59], v[168:171]
    s_waitcnt lgkmcnt(0)
    s_barrier
    v_mfma_f32_16x16x32_bf16 v[172:175], a[24:27], v[20:23], v[172:175]
    ds_read_b128 v[176:179], v213 offset:4096
    v_mfma_f32_16x16x32_bf16 v[172:175], a[28:31], v[24:27], v[172:175]
    s_lshl4_add_u32 s11, s63, s66
    v_mfma_f32_16x16x32_bf16 v[172:175], a[64:67], v[28:31], v[172:175]
    v_mfma_f32_16x16x32_bf16 v[172:175], a[68:71], v[32:35], v[172:175]
    v_mfma_f32_16x16x32_bf16 v[172:175], a[104:107], v[36:39], v[172:175]
    buffer_load_dwordx4 v[124:127], v216, s[32:35], s11 offen offset:0 sc1
    v_mfma_f32_16x16x32_bf16 v[172:175], a[108:111], v[40:43], v[172:175]
    buffer_store_dwordx4 v[168:171], v216, s[32:35], s28 offen offset:2048 sc1
    v_mfma_f32_16x16x32_bf16 v[172:175], a[144:147], v[44:47], v[172:175]
    v_mfma_f32_16x16x32_bf16 v[172:175], a[148:151], v[48:51], v[172:175]
    buffer_load_dwordx4 v[128:131], v216, s[32:35], s11 offen offset:1024 sc1
    v_mfma_f32_16x16x32_bf16 v[172:175], a[184:187], v[52:55], v[172:175]
    v_mfma_f32_16x16x32_bf16 v[172:175], a[188:191], v[56:59], v[172:175]
    s_waitcnt lgkmcnt(0)
    s_barrier
    v_mfma_f32_16x16x32_bf16 v[176:179], a[32:35], v[20:23], v[176:179]
    v_mfma_f32_16x16x32_bf16 v[176:179], a[36:39], v[24:27], v[176:179]
    s_lshl4_add_u32 s11, s64, s66
    v_mfma_f32_16x16x32_bf16 v[176:179], a[72:75], v[28:31], v[176:179]
    v_mfma_f32_16x16x32_bf16 v[176:179], a[76:79], v[32:35], v[176:179]
    v_mfma_f32_16x16x32_bf16 v[176:179], a[112:115], v[36:39], v[176:179]
    buffer_load_dwordx4 v[132:135], v216, s[32:35], s11 offen offset:0 sc1
    v_mfma_f32_16x16x32_bf16 v[176:179], a[116:119], v[40:43], v[176:179]
    buffer_store_dwordx4 v[172:175], v216, s[32:35], s28 offen offset:3072 sc1
    v_mfma_f32_16x16x32_bf16 v[176:179], a[152:155], v[44:47], v[176:179]
    v_mfma_f32_16x16x32_bf16 v[176:179], a[156:159], v[48:51], v[176:179]
    buffer_load_dwordx4 v[136:139], v216, s[32:35], s11 offen offset:1024 sc1
    v_mfma_f32_16x16x32_bf16 v[176:179], a[192:195], v[52:55], v[176:179]
    v_mfma_f32_16x16x32_bf16 v[176:179], a[196:199], v[56:59], v[176:179]
    s_waitcnt vmcnt(19)
    v_mfma_f32_16x16x32_bf16 v[140:143], a[0:3], v[60:63], 0
    v_mfma_f32_16x16x32_bf16 v[140:143], a[4:7], v[64:67], v[140:143]
    s_sub_u32 s12, s65, 2
    v_mfma_f32_16x16x32_bf16 v[140:143], a[40:43], v[68:71], v[140:143]
    s_and_b32 s12, s12, 3
    v_mfma_f32_16x16x32_bf16 v[140:143], a[44:47], v[72:75], v[140:143]
    s_mul_i32 s12, s12, 10240
    v_mfma_f32_16x16x32_bf16 v[140:143], a[80:83], v[76:79], v[140:143]
    s_add_u32 s66, s12, s85
    s_waitcnt vmcnt(14)
    v_mfma_f32_16x16x32_bf16 v[140:143], a[84:87], v[80:83], v[140:143]
    buffer_store_dwordx4 v[176:179], v216, s[32:35], s30 offen offset:0 sc1
    v_mfma_f32_16x16x32_bf16 v[140:143], a[120:123], v[84:87], v[140:143]
    s_lshl4_add_u32 s11, s60, s66
    v_mfma_f32_16x16x32_bf16 v[140:143], a[124:127], v[88:91], v[140:143]
    buffer_load_dwordx4 v[20:23], v216, s[32:35], s11 offen offset:0 sc1
    v_mfma_f32_16x16x32_bf16 v[140:143], a[160:163], v[92:95], v[140:143]
    buffer_load_dwordx4 v[24:27], v216, s[32:35], s11 offen offset:1024 sc1
    v_mfma_f32_16x16x32_bf16 v[140:143], a[164:167], v[96:99], v[140:143]
    v_mfma_f32_16x16x32_bf16 v[144:147], a[8:11], v[60:63], 0
    v_mfma_f32_16x16x32_bf16 v[144:147], a[12:15], v[64:67], v[144:147]
    s_lshl4_add_u32 s11, s61, s66
    v_mfma_f32_16x16x32_bf16 v[144:147], a[48:51], v[68:71], v[144:147]
    v_mfma_f32_16x16x32_bf16 v[144:147], a[52:55], v[72:75], v[144:147]
    v_mfma_f32_16x16x32_bf16 v[144:147], a[88:91], v[76:79], v[144:147]
    buffer_load_dwordx4 v[28:31], v216, s[32:35], s11 offen offset:0 sc1
    v_mfma_f32_16x16x32_bf16 v[144:147], a[92:95], v[80:83], v[144:147]
    ds_write_b128 v212, v[140:143] offset:0
    v_mfma_f32_16x16x32_bf16 v[144:147], a[128:131], v[84:87], v[144:147]
    v_mfma_f32_16x16x32_bf16 v[144:147], a[132:135], v[88:91], v[144:147]
    buffer_load_dwordx4 v[32:35], v216, s[32:35], s11 offen offset:1024 sc1
    v_mfma_f32_16x16x32_bf16 v[144:147], a[168:171], v[92:95], v[144:147]
    v_mfma_f32_16x16x32_bf16 v[144:147], a[172:175], v[96:99], v[144:147]
    v_mfma_f32_16x16x32_bf16 v[148:151], a[16:19], v[60:63], 0
    v_mfma_f32_16x16x32_bf16 v[148:151], a[20:23], v[64:67], v[148:151]
    s_lshl4_add_u32 s11, s62, s66
    v_mfma_f32_16x16x32_bf16 v[148:151], a[56:59], v[68:71], v[148:151]
    v_mfma_f32_16x16x32_bf16 v[148:151], a[60:63], v[72:75], v[148:151]
    v_mfma_f32_16x16x32_bf16 v[148:151], a[96:99], v[76:79], v[148:151]
    buffer_load_dwordx4 v[36:39], v216, s[32:35], s11 offen offset:0 sc1
    v_mfma_f32_16x16x32_bf16 v[148:151], a[100:103], v[80:83], v[148:151]
    ds_write_b128 v212, v[144:147] offset:1024
    v_mfma_f32_16x16x32_bf16 v[148:151], a[136:139], v[84:87], v[148:151]
    v_mfma_f32_16x16x32_bf16 v[148:151], a[140:143], v[88:91], v[148:151]
    buffer_load_dwordx4 v[40:43], v216, s[32:35], s11 offen offset:1024 sc1
    v_mfma_f32_16x16x32_bf16 v[148:151], a[176:179], v[92:95], v[148:151]
    v_mfma_f32_16x16x32_bf16 v[148:151], a[180:183], v[96:99], v[148:151]
    v_mfma_f32_16x16x32_bf16 v[152:155], a[24:27], v[60:63], 0
    v_mfma_f32_16x16x32_bf16 v[152:155], a[28:31], v[64:67], v[152:155]
    s_lshl4_add_u32 s11, s63, s66
    v_mfma_f32_16x16x32_bf16 v[152:155], a[64:67], v[68:71], v[152:155]
    v_mfma_f32_16x16x32_bf16 v[152:155], a[68:71], v[72:75], v[152:155]
    v_mfma_f32_16x16x32_bf16 v[152:155], a[104:107], v[76:79], v[152:155]
    buffer_load_dwordx4 v[44:47], v216, s[32:35], s11 offen offset:0 sc1
    v_mfma_f32_16x16x32_bf16 v[152:155], a[108:111], v[80:83], v[152:155]
    ds_write_b128 v212, v[148:151] offset:2048
    v_mfma_f32_16x16x32_bf16 v[152:155], a[144:147], v[84:87], v[152:155]
    v_mfma_f32_16x16x32_bf16 v[152:155], a[148:151], v[88:91], v[152:155]
    buffer_load_dwordx4 v[48:51], v216, s[32:35], s11 offen offset:1024 sc1
    v_mfma_f32_16x16x32_bf16 v[152:155], a[184:187], v[92:95], v[152:155]
    v_mfma_f32_16x16x32_bf16 v[152:155], a[188:191], v[96:99], v[152:155]
    s_waitcnt lgkmcnt(1)
    s_barrier
    v_mfma_f32_16x16x32_bf16 v[156:159], a[32:35], v[60:63], 0
    ds_read_b128 v[140:143], v213 offset:0
    v_mfma_f32_16x16x32_bf16 v[156:159], a[36:39], v[64:67], v[156:159]
    s_lshl4_add_u32 s11, s64, s66
    v_mfma_f32_16x16x32_bf16 v[156:159], a[72:75], v[68:71], v[156:159]
    v_mfma_f32_16x16x32_bf16 v[156:159], a[76:79], v[72:75], v[156:159]
    v_mfma_f32_16x16x32_bf16 v[156:159], a[112:115], v[76:79], v[156:159]
    buffer_load_dwordx4 v[52:55], v216, s[32:35], s11 offen offset:0 sc1
    v_mfma_f32_16x16x32_bf16 v[156:159], a[116:119], v[80:83], v[156:159]
    ds_write_b128 v212, v[152:155] offset:3072
    v_mfma_f32_16x16x32_bf16 v[156:159], a[152:155], v[84:87], v[156:159]
    v_mfma_f32_16x16x32_bf16 v[156:159], a[156:159], v[88:91], v[156:159]
    buffer_load_dwordx4 v[56:59], v216, s[32:35], s11 offen offset:1024 sc1
    v_mfma_f32_16x16x32_bf16 v[156:159], a[192:195], v[92:95], v[156:159]
    v_mfma_f32_16x16x32_bf16 v[156:159], a[196:199], v[96:99], v[156:159]
    s_waitcnt vmcnt(19)
    s_waitcnt lgkmcnt(1)
    s_waitcnt vmcnt(10)
    s_mov_b64 exec, 0xff
    buffer_store_dwordx4 v[252:255], v216, s[32:35], s86 offen sc1
    s_mov_b64 exec, -1
    v_mfma_f32_16x16x32_bf16 v[140:143], a[0:3], v[100:103], v[140:143]
    ds_read_b128 v[144:147], v213 offset:1024
    v_mfma_f32_16x16x32_bf16 v[140:143], a[4:7], v[104:107], v[140:143]
    s_sub_u32 s12, s65, 3
    v_mfma_f32_16x16x32_bf16 v[140:143], a[40:43], v[108:111], v[140:143]
    s_and_b32 s12, s12, 3
    v_mfma_f32_16x16x32_bf16 v[140:143], a[44:47], v[112:115], v[140:143]
    s_mul_i32 s12, s12, 10240
    v_mfma_f32_16x16x32_bf16 v[140:143], a[80:83], v[116:119], v[140:143]
    s_add_u32 s66, s12, s85
    v_mfma_f32_16x16x32_bf16 v[140:143], a[84:87], v[120:123], v[140:143]
    ds_write_b128 v212, v[156:159] offset:4096
    v_mfma_f32_16x16x32_bf16 v[140:143], a[120:123], v[124:127], v[140:143]
    s_lshl4_add_u32 s11, s60, s66
    v_mfma_f32_16x16x32_bf16 v[140:143], a[124:127], v[128:131], v[140:143]
    buffer_load_dwordx4 v[60:63], v216, s[32:35], s11 offen offset:0 sc1
    v_mfma_f32_16x16x32_bf16 v[140:143], a[160:163], v[132:135], v[140:143]
    buffer_load_dwordx4 v[64:67], v216, s[32:35], s11 offen offset:1024 sc1
    v_mfma_f32_16x16x32_bf16 v[140:143], a[164:167], v[136:139], v[140:143]
    s_waitcnt lgkmcnt(1)
    s_barrier
    v_mfma_f32_16x16x32_bf16 v[144:147], a[8:11], v[100:103], v[144:147]
    ds_read_b128 v[148:151], v213 offset:2048
    v_mfma_f32_16x16x32_bf16 v[144:147], a[12:15], v[104:107], v[144:147]
    s_lshl4_add_u32 s11, s61, s66
    v_mfma_f32_16x16x32_bf16 v[144:147], a[48:51], v[108:111], v[144:147]
    v_mfma_f32_16x16x32_bf16 v[144:147], a[52:55], v[112:115], v[144:147]
    v_mfma_f32_16x16x32_bf16 v[144:147], a[88:91], v[116:119], v[144:147]
    buffer_load_dwordx4 v[68:71], v216, s[32:35], s11 offen offset:0 sc1
    v_mfma_f32_16x16x32_bf16 v[144:147], a[92:95], v[120:123], v[144:147]
    ds_write_b128 v212, v[140:143] offset:5120
    v_mfma_f32_16x16x32_bf16 v[144:147], a[128:131], v[124:127], v[144:147]
    v_mfma_f32_16x16x32_bf16 v[144:147], a[132:135], v[128:131], v[144:147]
    buffer_load_dwordx4 v[72:75], v216, s[32:35], s11 offen offset:1024 sc1
    v_mfma_f32_16x16x32_bf16 v[144:147], a[168:171], v[132:135], v[144:147]
    v_mfma_f32_16x16x32_bf16 v[144:147], a[172:175], v[136:139], v[144:147]
    s_waitcnt lgkmcnt(1)
    v_mfma_f32_16x16x32_bf16 v[148:151], a[16:19], v[100:103], v[148:151]
    ds_read_b128 v[152:155], v213 offset:3072
    v_mfma_f32_16x16x32_bf16 v[148:151], a[20:23], v[104:107], v[148:151]
    s_lshl4_add_u32 s11, s62, s66
    v_mfma_f32_16x16x32_bf16 v[148:151], a[56:59], v[108:111], v[148:151]
    v_mfma_f32_16x16x32_bf16 v[148:151], a[60:63], v[112:115], v[148:151]
    v_mfma_f32_16x16x32_bf16 v[148:151], a[96:99], v[116:119], v[148:151]
    buffer_load_dwordx4 v[76:79], v216, s[32:35], s11 offen offset:0 sc1
    v_mfma_f32_16x16x32_bf16 v[148:151], a[100:103], v[120:123], v[148:151]
    ds_write_b128 v212, v[144:147] offset:6144
    v_mfma_f32_16x16x32_bf16 v[148:151], a[136:139], v[124:127], v[148:151]
    v_mfma_f32_16x16x32_bf16 v[148:151], a[140:143], v[128:131], v[148:151]
    buffer_load_dwordx4 v[80:83], v216, s[32:35], s11 offen offset:1024 sc1
    v_mfma_f32_16x16x32_bf16 v[148:151], a[176:179], v[132:135], v[148:151]
    v_mfma_f32_16x16x32_bf16 v[148:151], a[180:183], v[136:139], v[148:151]
    s_waitcnt lgkmcnt(1)
    s_barrier
    v_mfma_f32_16x16x32_bf16 v[152:155], a[24:27], v[100:103], v[152:155]
    ds_read_b128 v[156:159], v213 offset:4096
    v_mfma_f32_16x16x32_bf16 v[152:155], a[28:31], v[104:107], v[152:155]
    s_lshl4_add_u32 s11, s63, s66
    v_mfma_f32_16x16x32_bf16 v[152:155], a[64:67], v[108:111], v[152:155]
    v_mfma_f32_16x16x32_bf16 v[152:155], a[68:71], v[112:115], v[152:155]
    v_mfma_f32_16x16x32_bf16 v[152:155], a[104:107], v[116:119], v[152:155]
    buffer_load_dwordx4 v[84:87], v216, s[32:35], s11 offen offset:0 sc1
    v_mfma_f32_16x16x32_bf16 v[152:155], a[108:111], v[120:123], v[152:155]
    ds_write_b128 v212, v[148:151] offset:7168
    v_mfma_f32_16x16x32_bf16 v[152:155], a[144:147], v[124:127], v[152:155]
    v_mfma_f32_16x16x32_bf16 v[152:155], a[148:151], v[128:131], v[152:155]
    buffer_load_dwordx4 v[88:91], v216, s[32:35], s11 offen offset:1024 sc1
    v_mfma_f32_16x16x32_bf16 v[152:155], a[184:187], v[132:135], v[152:155]
    v_mfma_f32_16x16x32_bf16 v[152:155], a[188:191], v[136:139], v[152:155]
    s_waitcnt lgkmcnt(1)
    buffer_load_dword v242, v249, s[32:35], s87 offen offset:4 sc1
    v_mfma_f32_16x16x32_bf16 v[156:159], a[32:35], v[100:103], v[156:159]
    ds_read_b128 v[140:143], v213 offset:5120
    v_mfma_f32_16x16x32_bf16 v[156:159], a[36:39], v[104:107], v[156:159]
    s_lshl4_add_u32 s11, s64, s66
    v_mfma_f32_16x16x32_bf16 v[156:159], a[72:75], v[108:111], v[156:159]
    v_mfma_f32_16x16x32_bf16 v[156:159], a[76:79], v[112:115], v[156:159]
    v_mfma_f32_16x16x32_bf16 v[156:159], a[112:115], v[116:119], v[156:159]
    buffer_load_dwordx4 v[92:95], v216, s[32:35], s11 offen offset:0 sc1
    v_mfma_f32_16x16x32_bf16 v[156:159], a[116:119], v[120:123], v[156:159]
    ds_write_b128 v212, v[152:155] offset:8192
    v_mfma_f32_16x16x32_bf16 v[156:159], a[152:155], v[124:127], v[156:159]
    v_mfma_f32_16x16x32_bf16 v[156:159], a[156:159], v[128:131], v[156:159]
    buffer_load_dwordx4 v[96:99], v216, s[32:35], s11 offen offset:1024 sc1
    v_mfma_f32_16x16x32_bf16 v[156:159], a[192:195], v[132:135], v[156:159]
    v_mfma_f32_16x16x32_bf16 v[156:159], a[196:199], v[136:139], v[156:159]
    s_waitcnt vmcnt(17)
    s_waitcnt lgkmcnt(1)
    s_barrier
    v_mfma_f32_16x16x32_bf16 v[140:143], a[0:3], v[20:23], v[140:143]
    ds_read_b128 v[144:147], v213 offset:6144
    v_mfma_f32_16x16x32_bf16 v[140:143], a[4:7], v[24:27], v[140:143]
    v_mfma_f32_16x16x32_bf16 v[140:143], a[40:43], v[28:31], v[140:143]
    v_mfma_f32_16x16x32_bf16 v[140:143], a[44:47], v[32:35], v[140:143]
    v_mfma_f32_16x16x32_bf16 v[140:143], a[80:83], v[36:39], v[140:143]
    s_waitcnt vmcnt(12)
    v_mfma_f32_16x16x32_bf16 v[140:143], a[84:87], v[40:43], v[140:143]
    ds_write_b128 v212, v[156:159] offset:9216
    v_mfma_f32_16x16x32_bf16 v[140:143], a[120:123], v[44:47], v[140:143]
    v_mfma_f32_16x16x32_bf16 v[140:143], a[124:127], v[48:51], v[140:143]
    v_mfma_f32_16x16x32_bf16 v[140:143], a[160:163], v[52:55], v[140:143]
    v_mfma_f32_16x16x32_bf16 v[140:143], a[164:167], v[56:59], v[140:143]
    s_waitcnt lgkmcnt(1)
    v_mfma_f32_16x16x32_bf16 v[144:147], a[8:11], v[20:23], v[144:147]
    ds_read_b128 v[148:151], v213 offset:7168
    v_mfma_f32_16x16x32_bf16 v[144:147], a[12:15], v[24:27], v[144:147]
    v_mfma_f32_16x16x32_bf16 v[144:147], a[48:51], v[28:31], v[144:147]
    v_mfma_f32_16x16x32_bf16 v[144:147], a[52:55], v[32:35], v[144:147]
    v_mfma_f32_16x16x32_bf16 v[144:147], a[88:91], v[36:39], v[144:147]
    v_mfma_f32_16x16x32_bf16 v[144:147], a[92:95], v[40:43], v[144:147]
    ds_write_b128 v212, v[140:143] offset:0
    v_mfma_f32_16x16x32_bf16 v[144:147], a[128:131], v[44:47], v[144:147]
    v_mfma_f32_16x16x32_bf16 v[144:147], a[132:135], v[48:51], v[144:147]
    v_mfma_f32_16x16x32_bf16 v[144:147], a[168:171], v[52:55], v[144:147]
    v_mfma_f32_16x16x32_bf16 v[144:147], a[172:175], v[56:59], v[144:147]
    s_waitcnt lgkmcnt(1)
    s_barrier
    v_mfma_f32_16x16x32_bf16 v[148:151], a[16:19], v[20:23], v[148:151]
    ds_read_b128 v[152:155], v213 offset:8192
    v_mfma_f32_16x16x32_bf16 v[148:151], a[20:23], v[24:27], v[148:151]
    v_mfma_f32_16x16x32_bf16 v[148:151], a[56:59], v[28:31], v[148:151]
    v_mfma_f32_16x16x32_bf16 v[148:151], a[60:63], v[32:35], v[148:151]
    v_mfma_f32_16x16x32_bf16 v[148:151], a[96:99], v[36:39], v[148:151]
    v_mfma_f32_16x16x32_bf16 v[148:151], a[100:103], v[40:43], v[148:151]
    ds_write_b128 v212, v[144:147] offset:1024
    v_mfma_f32_16x16x32_bf16 v[148:151], a[136:139], v[44:47], v[148:151]
    v_mfma_f32_16x16x32_bf16 v[148:151], a[140:143], v[48:51], v[148:151]
    v_mfma_f32_16x16x32_bf16 v[148:151], a[176:179], v[52:55], v[148:151]
    v_mfma_f32_16x16x32_bf16 v[148:151], a[180:183], v[56:59], v[148:151]
    s_waitcnt lgkmcnt(1)
    s_waitcnt vmcnt(2)
    v_cmp_ne_u32_e64 vcc, s10, v242
    s_cbranch_vccz L_got3
L_poll3:
    buffer_load_dword v242, v249, s[32:35], s87 offen offset:4 sc1
    s_sub_u32 s3, s3, 1
    s_waitcnt vmcnt(0)
    v_cmp_ne_u32 vcc, s10, v242
    s_cmp_eq_u32 s3, 0
    s_cbranch_scc1 L_got3
    s_cbranch_vccnz L_poll3
L_got3:
    buffer_load_dwordx4 v[160:163], v216, s[32:35], s29 offen offset:0 sc1
    buffer_load_dwordx4 v[164:167], v216, s[32:35], s29 offen offset:1024 sc1
    buffer_load_dwordx4 v[168:171], v216, s[32:35], s29 offen offset:2048 sc1
    buffer_load_dwordx4 v[172:175], v216, s[32:35], s29 offen offset:3072 sc1
    buffer_load_dwordx4 v[176:179], v216, s[32:35], s31 offen offset:0 sc1
    v_mfma_f32_16x16x32_bf16 v[152:155], a[24:27], v[20:23], v[152:155]
    ds_read_b128 v[156:159], v213 offset:9216
    v_mfma_f32_16x16x32_bf16 v[152:155], a[28:31], v[24:27], v[152:155]
    v_mfma_f32_16x16x32_bf16 v[152:155], a[64:67], v[28:31], v[152:155]
    v_mfma_f32_16x16x32_bf16 v[152:155], a[68:71], v[32:35], v[152:155]
    v_mfma_f32_16x16x32_bf16 v[152:155], a[104:107], v[36:39], v[152:155]
    v_mfma_f32_16x16x32_bf16 v[152:155], a[108:111], v[40:43], v[152:155]
    ds_write_b128 v212, v[148:151] offset:2048
    v_mfma_f32_16x16x32_bf16 v[152:155], a[144:147], v[44:47], v[152:155]
    v_mfma_f32_16x16x32_bf16 v[152:155], a[148:151], v[48:51], v[152:155]
    v_mfma_f32_16x16x32_bf16 v[152:155], a[184:187], v[52:55], v[152:155]
    v_mfma_f32_16x16x32_bf16 v[152:155], a[188:191], v[56:59], v[152:155]
    s_waitcnt lgkmcnt(1)
    s_barrier
    v_mfma_f32_16x16x32_bf16 v[156:159], a[32:35], v[20:23], v[156:159]
    ds_read_b128 v[140:143], v213 offset:0
    v_mfma_f32_16x16x32_bf16 v[156:159], a[36:39], v[24:27], v[156:159]
    v_mfma_f32_16x16x32_bf16 v[156:159], a[72:75], v[28:31], v[156:159]
    v_mfma_f32_16x16x32_bf16 v[156:159], a[76:79], v[32:35], v[156:159]
    v_mfma_f32_16x16x32_bf16 v[156:159], a[112:115], v[36:39], v[156:159]
    v_mfma_f32_16x16x32_bf16 v[156:159], a[116:119], v[40:43], v[156:159]
    ds_write_b128 v212, v[152:155] offset:3072
    v_mfma_f32_16x16x32_bf16 v[156:159], a[152:155], v[44:47], v[156:159]
    v_mfma_f32_16x16x32_bf16 v[156:159], a[156:159], v[48:51], v[156:159]
    v_mfma_f32_16x16x32_bf16 v[156:159], a[192:195], v[52:55], v[156:159]
    v_mfma_f32_16x16x32_bf16 v[156:159], a[196:199], v[56:59], v[156:159]
    s_waitcnt lgkmcnt(1)
    v_mfma_f32_16x16x32_bf16 v[140:143], a[0:3], v[60:63], v[140:143]
    ds_read_b128 v[144:147], v213 offset:1024
    v_mfma_f32_16x16x32_bf16 v[140:143], a[4:7], v[64:67], v[140:143]
    v_mfma_f32_16x16x32_bf16 v[140:143], a[40:43], v[68:71], v[140:143]
    v_mfma_f32_16x16x32_bf16 v[140:143], a[44:47], v[72:75], v[140:143]
    v_mfma_f32_16x16x32_bf16 v[140:143], a[80:83], v[76:79], v[140:143]
    s_waitcnt vmcnt(5)
    v_mfma_f32_16x16x32_bf16 v[140:143], a[84:87], v[80:83], v[140:143]
    ds_write_b128 v212, v[156:159] offset:4096
    v_mfma_f32_16x16x32_bf16 v[140:143], a[120:123], v[84:87], v[140:143]
    v_mfma_f32_16x16x32_bf16 v[140:143], a[124:127], v[88:91], v[140:143]
    v_mfma_f32_16x16x32_bf16 v[140:143], a[160:163], v[92:95], v[140:143]
    v_mfma_f32_16x16x32_bf16 v[140:143], a[164:167], v[96:99], v[140:143]
    s_waitcnt lgkmcnt(1)
    s_barrier
    v_mfma_f32_16x16x32_bf16 v[144:147], a[8:11], v[60:63], v[144:147]
    ds_read_b128 v[148:151], v213 offset:2048
    v_mfma_f32_16x16x32_bf16 v[144:147], a[12:15], v[64:67], v[144:147]
    v_mfma_f32_16x16x32_bf16 v[144:147], a[48:51], v[68:71], v[144:147]
    v_mfma_f32_16x16x32_bf16 v[144:147], a[52:55], v[72:75], v[144:147]
    v_mfma_f32_16x16x32_bf16 v[144:147], a[88:91], v[76:79], v[144:147]
    v_mfma_f32_16x16x32_bf16 v[144:147], a[92:95], v[80:83], v[144:147]
    v_mfma_f32_16x16x32_bf16 v[144:147], a[128:131], v[84:87], v[144:147]
    v_mfma_f32_16x16x32_bf16 v[144:147], a[132:135], v[88:91], v[144:147]
    v_mfma_f32_16x16x32_bf16 v[144:147], a[168:171], v[92:95], v[144:147]
    v_mfma_f32_16x16x32_bf16 v[144:147], a[172:175], v[96:99], v[144:147]
    s_waitcnt lgkmcnt(0)
    v_mfma_f32_16x16x32_bf16 v[148:151], a[16:19], v[60:63], v[148:151]
    ds_read_b128 v[152:155], v213 offset:3072
    s_waitcnt vmcnt(4)
    v_mfma_f32_16x16x32_bf16 v[148:151], a[20:23], v[64:67], v[148:151]
    v_fmac_f32 v180, v221, v160
    v_fmac_f32 v181, v221, v161
    v_mfma_f32_16x16x32_bf16 v[148:151], a[56:59], v[68:71], v[148:151]
    v_fmac_f32 v182, v221, v162
    v_fmac_f32 v183, v221, v163
    v_mfma_f32_16x16x32_bf16 v[148:151], a[60:63], v[72:75], v[148:151]
    v_fmac_f32 v180, v220, v140
    v_fmac_f32 v181, v220, v141
    v_mfma_f32_16x16x32_bf16 v[148:151], a[96:99], v[76:79], v[148:151]
    v_fmac_f32 v182, v220, v142
    v_fmac_f32 v183, v220, v143
    v_mfma_f32_16x16x32_bf16 v[148:151], a[100:103], v[80:83], v[148:151]
    ds_bpermute_b32 v160, v215, v180
    ds_bpermute_b32 v161, v215, v181
    v_mfma_f32_16x16x32_bf16 v[148:151], a[136:139], v[84:87], v[148:151]
    ds_bpermute_b32 v162, v215, v182
    ds_bpermute_b32 v163, v215, v183
    v_mfma_f32_16x16x32_bf16 v[148:151], a[140:143], v[88:91], v[148:151]
    v_mfma_f32_16x16x32_bf16 v[148:151], a[176:179], v[92:95], v[148:151]
    v_mfma_f32_16x16x32_bf16 v[148:151], a[180:183], v[96:99], v[148:151]
    s_waitcnt lgkmcnt(4)
    s_barrier
    v_mfma_f32_16x16x32_bf16 v[152:155], a[24:27], v[60:63], v[152:155]
    ds_read_b128 v[156:159], v213 offset:4096
    s_waitcnt vmcnt(3)
    v_mfma_f32_16x16x32_bf16 v[152:155], a[28:31], v[64:67], v[152:155]
    s_waitcnt lgkmcnt(1)
    v_fmac_f32_e64 v184, v221, v164
    v_mfma_f32_16x16x32_bf16 v[152:155], a[64:67], v[68:71], v[152:155]
    v_fmac_f32 v185, v221, v165
    v_fmac_f32 v186, v221, v166
    v_mfma_f32_16x16x32_bf16 v[152:155], a[68:71], v[72:75], v[152:155]
    buffer_store_dwordx4 v[160:163], v3, s[36:39], 0 offen offset:0
    v_fmac_f32_e64 v187, v221, v167
    v_mfma_f32_16x16x32_bf16 v[152:155], a[104:107], v[76:79], v[152:155]
    v_fmac_f32 v184, v220, v144
    v_fmac_f32 v185, v220, v145
    v_mfma_f32_16x16x32_bf16 v[152:155], a[108:111], v[80:83], v[152:155]
    v_fmac_f32 v186, v220, v146
    v_fmac_f32 v187, v220, v147
    v_mfma_f32_16x16x32_bf16 v[152:155], a[144:147], v[84:87], v[152:155]
    ds_bpermute_b32 v164, v215, v184
    ds_bpermute_b32 v165, v215, v185
    v_mfma_f32_16x16x32_bf16 v[152:155], a[148:151], v[88:91], v[152:155]
    ds_bpermute_b32 v166, v215, v186
    ds_bpermute_b32 v167, v215, v187
    v_mfma_f32_16x16x32_bf16 v[152:155], a[184:187], v[92:95], v[152:155]
    v_mfma_f32_16x16x32_bf16 v[152:155], a[188:191], v[96:99], v[152:155]
    s_waitcnt lgkmcnt(4)
    v_mfma_f32_16x16x32_bf16 v[156:159], a[32:35], v[60:63], v[156:159]
    s_waitcnt vmcnt(3)
    v_fmac_f32_e64 v188, v221, v168
    v_mfma_f32_16x16x32_bf16 v[156:159], a[36:39], v[64:67], v[156:159]
    s_waitcnt lgkmcnt(0)
    v_fmac_f32 v189, v221, v169
    v_mfma_f32_16x16x32_bf16 v[156:159], a[72:75], v[68:71], v[156:159]
    v_fmac_f32 v190, v221, v170
    v_fmac_f32 v191, v221, v171
    v_mfma_f32_16x16x32_bf16 v[156:159], a[76:79], v[72:75], v[156:159]
    buffer_store_dwordx4 v[164:167], v3, s[36:39], 0 offen offset:64
    v_fmac_f32_e64 v188, v220, v148
    v_mfma_f32_16x16x32_bf16 v[156:159], a[112:115], v[76:79], v[156:159]
    v_fmac_f32 v189, v220, v149
    v_fmac_f32 v190, v220, v150
    v_mfma_f32_16x16x32_bf16 v[156:159], a[116:119], v[80:83], v[156:159]
    v_fmac_f32_e64 v191, v220, v151
    ds_bpermute_b32 v168, v215, v188
    v_mfma_f32_16x16x32_bf16 v[156:159], a[152:155], v[84:87], v[156:159]
    ds_bpermute_b32 v169, v215, v189
    ds_bpermute_b32 v170, v215, v190
    v_mfma_f32_16x16x32_bf16 v[156:159], a[156:159], v[88:91], v[156:159]
    ds_bpermute_b32 v171, v215, v191
    v_mfma_f32_16x16x32_bf16 v[156:159], a[192:195], v[92:95], v[156:159]
    v_mfma_f32_16x16x32_bf16 v[156:159], a[196:199], v[96:99], v[156:159]
    s_waitcnt vmcnt(3)
    v_fmac_f32 v192, v221, v172
    v_fmac_f32 v193, v221, v173
    v_fmac_f32 v194, v221, v174
    v_fmac_f32 v195, v221, v175
    s_waitcnt vmcnt(2)
    v_fmac_f32 v196, v221, v176
    v_fmac_f32 v197, v221, v177
    v_fmac_f32 v198, v221, v178
    v_fmac_f32_e64 v199, v221, v179
    s_waitcnt lgkmcnt(0)
    buffer_store_dwordx4 v[168:171], v3, s[36:39], 0 offen offset:128
    v_fmac_f32 v192, v220, v152
    v_fmac_f32 v193, v220, v153
    v_fmac_f32 v194, v220, v154
    v_fmac_f32 v195, v220, v155
    ds_bpermute_b32 v172, v215, v192
    ds_bpermute_b32 v173, v215, v193
    ds_bpermute_b32 v174, v215, v194
    ds_bpermute_b32 v175, v215, v195
    v_fmac_f32 v196, v220, v156
    v_fmac_f32 v197, v220, v157
    v_fmac_f32 v198, v220, v158
    v_fmac_f32 v199, v220, v159
    ds_bpermute_b32 v176, v215, v196
    ds_bpermute_b32 v177, v215, v197
    ds_bpermute_b32 v178, v215, v198
    ds_bpermute_b32 v179, v215, v199
    s_waitcnt lgkmcnt(4)
    buffer_store_dwordx4 v[172:175], v3, s[36:39], 0 offen offset:192
    s_waitcnt lgkmcnt(0)
    buffer_store_dwordx4 v[176:179], v3, s[36:39], 0 offen offset:256
    s_xor_b32 s12, s4, 15
    s_or_b32 s12, s12, s5
    s_or_b32 s12, s12, s8
    s_cbranch_scc1 L_noep
    s_mov_b64 exec, 1
    buffer_store_dword v248, v249, s[32:35], 0 offen offset:0
    s_mov_b64 exec, -1
L_noep:
L_end:
    s_endpgm
L_last:
    s_endpgm
.section .rodata,"a"
.p2align 6
.amdhsa_kernel gated_mix__ssm_conv_s5__ssm_conv_s5__prompt_kernel
  .amdhsa_next_free_vgpr 512
  .amdhsa_next_free_sgpr 102
  .amdhsa_accum_offset 256
  .amdhsa_group_segment_fixed_size 0
  .amdhsa_kernarg_size 176
  .amdhsa_user_sgpr_count 2
  .amdhsa_user_sgpr_kernarg_segment_ptr 1
  .amdhsa_system_sgpr_workgroup_id_x 1
  .amdhsa_float_denorm_mode_32 3
.end_amdhsa_kernel
```
